```python
import torch

def _softmax(x, axis=-1):
    return torch.softmax(x, dim=axis)

def _gelu(x):
    return torch.nn.functional.gelu(x, approximate='tanh')

def _silu(x):
    return torch.nn.functional.silu(x)

def _sigmoid(x):
    return torch.sigmoid(x)

def _layernorm(x, axis=-1, eps=1e-05):
    m = x.mean(dim=axis, keepdim=True)
    v = x.var(dim=axis, keepdim=True, unbiased=False)
    return (x - m) / torch.sqrt(v + eps)

def _scatter_add(tgt, idx, src, axis=0):
    return tgt.clone().index_add_(axis, idx, src)

def _segment_sum(src, seg, n):
    out = torch.zeros((n,) + src.shape[1:], dtype=src.dtype)
    return out.index_add_(0, seg, src)

def _pad(x, pw):
    flat = tuple((v for pair in reversed(pw) for v in pair))
    return torch.nn.functional.pad(x, flat)
kernel_name = 'gated_mix__sliding_local_dilated__mixer_gmlp__prompt'

def setup_inputs():

    _w = lambda a: (lambda t: t.to(torch.bfloat16) if t.is_floating_point() else t)(torch.as_tensor(a))

    def _A_setup():
        B, S, D = (1, 2048, 512)
        return {'x': _w((lambda *s: torch.randn(*s, dtype=torch.bfloat16) * 0.05)(B, S, D)), 'wqkv': _w((lambda *s: torch.randn(*s, dtype=torch.bfloat16) * 0.8)(D, 3 * D)), 'wo': _w((lambda *s: torch.randn(*s, dtype=torch.bfloat16) * 0.05)(D, D))}
    _A_in = _A_setup()

    def _B_setup():
        B, S, D, F = (1, 2048, 512, 1792)
        Fh = F // 2
        return {'x': _w((lambda *s: torch.randn(*s, dtype=torch.bfloat16) * 0.05)(B, S, D)), 'w_in': _w((lambda *s: torch.randn(*s, dtype=torch.bfloat16) * 0.4)(D, 2 * Fh)), 'w_sp': _w(0.01 * (lambda *s: torch.randn(*s, dtype=torch.bfloat16) * 0.4)(S, S)), 'b_sp': _w(1.0 + 0.01 * (lambda *s: torch.randn(*s, dtype=torch.bfloat16) * 0.1)(S)), 'w_out': _w((lambda *s: torch.randn(*s, dtype=torch.bfloat16) * 0.1)(Fh, D))}
    _B_in = _B_setup()
    return {'A_x': _A_in['x'], 'A_wqkv': _A_in['wqkv'], 'A_wo': _A_in['wo'], 'B_x': _B_in['x'], 'B_w_in': _B_in['w_in'], 'B_w_sp': _B_in['w_sp'], 'B_b_sp': _B_in['b_sp'], 'B_w_out': _B_in['w_out'], 'gate_w': _w((lambda *s: torch.randn(*s, dtype=torch.bfloat16) * 0.05)(512) * 16.0)}

def reference(A_x, A_wqkv, A_wo, B_x, B_w_in, B_w_sp, B_b_sp, B_w_out, gate_w):

    def _A_ref(x, wqkv, wo):
        B, S, D = x.shape
        H = 32
        Dh = D // H
        W, dil = (8, 2)
        qkv = (lambda x, *d: x.permute(*d))((x @ wqkv).reshape(B, S, 3, H, Dh), 2, 0, 3, 1, 4)
        q, k, v = (qkv[0], qkv[1], qkv[2])
        scale = Dh ** (-0.5)
        pos = torch.arange(S)
        off = torch.arange(W) * dil
        idx = pos[:, None] - off[None, :]
        mask = idx >= 0
        idx_c = torch.where(mask, idx, 0).reshape(-1)
        kg = k[:, :, idx_c, :].reshape(B, H, S, W, Dh)
        vg = v[:, :, idx_c, :].reshape(B, H, S, W, Dh)
        logits = torch.einsum('bhsd,bhswd->bhsw', q, kg) * scale
        logits = torch.where(mask[None, None, :, :], logits, -1000000000.0)
        attn = _softmax(logits, axis=-1)
        o = torch.einsum('bhsw,bhswd->bhsd', attn, vg)
        return (lambda x, *d: x.permute(*d))(o, 0, 2, 1, 3).reshape(B, S, D) @ wo

    def _B_ref(x, w_in, w_sp, b_sp, w_out):
        B, S, D = x.shape
        F = w_in.shape[-1]
        Fh = F // 2
        z = _gelu(torch.einsum('bsd,df->bsf', x, w_in))
        z1 = z[..., :Fh].clone()
        z2 = _layernorm(z[..., Fh:], axis=-1)
        g = torch.einsum('ts,bsf->btf', w_sp, z2) + b_sp[None, :, None]
        return torch.einsum('bsf,fd->bsd', z1 * g, w_out)
    x = A_x
    g = _sigmoid((x * gate_w).sum(-1, keepdims=True))
    a = _A_ref(x, A_wqkv, A_wo)
    b = _B_ref(x, B_w_in, B_w_sp, B_b_sp, B_w_out)
    return g * a + (1 - g) * b
```

```asm
; @launch grid=(256,1,1) block=(512,1,1) lds=163840
.amdgcn_target "amdgcn-amd-amdhsa--gfx950"
.text
.globl gated_mix__sliding_local_dilated__mixer_gmlp__prompt_kernel
.p2align 8
.type gated_mix__sliding_local_dilated__mixer_gmlp__prompt_kernel,@function
gated_mix__sliding_local_dilated__mixer_gmlp__prompt_kernel:
    s_load_dwordx16 s[64:79], s[0:1], 0
    s_load_dwordx8 s[80:87], s[0:1], 64
    s_cmp_ge_u32 s2, 256
    s_cbranch_scc1 fk_end
    v_lshrrev_b32 v4, 6, v0
    v_and_b32 v1, 63, v0
    v_and_b32 v2, 15, v0
    v_readfirstlane_b32 s20, v4
    v_lshrrev_b32 v3, 4, v1
    s_and_b32 s27, s2, 1
    s_lshr_b32 s25, s2, 3
    s_bfe_u32 s21, s2, 0x10001
    s_lshl_b32 s21, s21, 3
    s_and_b32 s26, s25, 7
    s_add_u32 s21, s21, s26
    s_bfe_u32 s22, s2, 0x10002
    s_lshl_b32 s22, s22, 2
    s_lshr_b32 s28, s25, 3
    s_add_u32 s22, s22, s28
    s_lshl_b32 s23, s28, 1
    s_add_u32 s23, s23, s26
    s_lshr_b32 s3, s2, 1
    s_and_b32 s44, s2, 7
    s_lshl_b32 s44, s44, 2
    s_and_b32 s24, s25, 3
    s_add_u32 s44, s44, s24
    s_lshr_b32 s45, s25, 2
    s_and_b32 s29, s20, 3
    s_mov_b32 s6, 0x200000
    s_mov_b32 s7, 0x20000
    s_or_b32 s36, s2, s20
    s_cmp_lg_u32 s36, 0
    s_cbranch_scc1 f_notag
    s_memrealtime s[36:37]
    v_mov_b32 v246, 0
    s_waitcnt lgkmcnt(0)
    s_or_b32 s36, s36, 1
    v_mov_b32 v244, s36
    v_mov_b32 v245, s37
    s_mov_b64 exec, 1
    global_store_dwordx2 v246, v[244:245], s[84:85] sc0 sc1
    s_mov_b64 exec, -1
f_notag:
    s_cmp_lt_u32 s20, 4
    s_cbranch_scc1 f_comp
    s_setprio 3
    s_and_b32 s24, s29, 1
    s_lshr_b32 s25, s29, 1
    s_lshl_b32 s26, s24, 4
    s_add_u32 s26, s26, s25
    v_lshrrev_b32 v6, 3, v1
    v_lshlrev_b32 v6, 1, v6
    v_add_u32 v6, s26, v6
    v_lshlrev_b32 v6, 10, v6
    s_lshl_b32 s24, s24, 2
    v_lshrrev_b32 v7, 4, v1
    v_add_u32 v7, s24, v7
    v_and_b32 v8, 7, v1
    v_xor_b32 v8, v8, v7
    v_lshl_add_u32 v8, v8, 4, v6
    s_cmp_eq_u32 s27, 1
    s_movk_i32 s40, 3072
    s_cselect_b32 s40, s40, 3584
    v_lshrrev_b32 v7, 3, v1
    s_lshl_b32 s24, s29, 3
    v_add_u32 v7, s24, v7
    v_mul_lo_u32 v7, v7, s40
    v_bfe_u32 v6, v1, 4, 1
    s_and_b32 s24, s29, 1
    s_lshl_b32 s24, s24, 1
    v_or_b32 v6, s24, v6
    v_bfe_u32 v9, v1, 1, 2
    v_xor_b32 v6, v6, v9
    v_and_b32 v9, 1, v1
    v_lshl_or_b32 v9, v6, 1, v9
    v_lshl_add_u32 v9, v9, 4, v7
    v_cmp_eq_u32 vcc, 3, v6
    v_bfrev_b32 v7, 1
    s_lshl_b32 s32, s21, 17
    s_lshl_b32 s34, s29, 10
    v_cndmask_b32 v10, v9, v7, vcc
    s_mov_b32 s30, 0
    s_mov_b32 s31, 0
    s_lshl_b32 s10, s40, 9
    s_mov_b32 s11, 0x20000
    s_mul_i32 s33, s22, 224
    s_cmp_eq_u32 s27, 1
    s_waitcnt lgkmcnt(0)
    s_mov_b32 s4, s64
    s_mov_b32 s5, s65
    s_cselect_b32 s8, s66, s72
    s_cselect_b32 s9, s67, s73
    s_cbranch_scc1 f_aload
    s_getpc_b64 s[56:57]
f_mret0:
    s_add_u32 s56, s56, f_mprog - f_mret0
    s_addc_u32 s57, s57, 0
    s_and_b32 s30, s23, 7
    s_mov_b32 s31, s30
    s_add_u32 s33, s33, 1792
    s_add_u32 s38, s34, 147456
    s_add_u32 s46, s34, 49152
    s_mov_b32 s51, 1
f_mx:
    s_and_b32 s35, s30, 7
    s_lshl_b32 s36, s35, 7
    s_add_u32 s36, s36, s32
    s_add_u32 s30, s30, 1
    s_add_u32 m0, s38, 0
    s_add_u32 s39, s36, 0
    buffer_load_dwordx4 v8, s[4:7], s39 offen lds
    s_add_u32 m0, s38, 4096
    s_add_u32 s39, s36, 32768
    buffer_load_dwordx4 v8, s[4:7], s39 offen lds
    s_add_u32 m0, s38, 8192
    s_add_u32 s39, s36, 65536
    buffer_load_dwordx4 v8, s[4:7], s39 offen lds
    s_add_u32 m0, s38, 12288
    s_add_u32 s39, s36, 98304
    buffer_load_dwordx4 v8, s[4:7], s39 offen lds
    s_cmp_eq_u32 s51, 0
    s_cbranch_scc1 f_mwr
f_mw:
    s_and_b32 s35, s31, 7
    s_mul_i32 s37, s35, 229376
    s_add_u32 s37, s37, s33
    s_add_u32 s31, s31, 1
    s_add_u32 m0, s46, 0
    s_add_u32 s39, s37, 0
    buffer_load_dwordx4 v9, s[8:11], s39 offen lds
    s_add_u32 m0, s46, 4096
    s_add_u32 s39, s37, 114688
    buffer_load_dwordx4 v9, s[8:11], s39 offen lds
    s_add_u32 m0, s46, 8192
    s_add_u32 s39, s37, 128
    buffer_load_dwordx4 v10, s[8:11], s39 offen lds
    s_add_u32 m0, s46, 12288
    s_add_u32 s39, s37, 114816
    buffer_load_dwordx4 v10, s[8:11], s39 offen lds
f_mwr:
    s_setpc_b64 s[56:57]
f_aload:
    s_sub_u32 s33, s32, 32768
    s_max_i32 s33, s33, 0
    s_lshl_b32 s54, s22, 7
    s_getpc_b64 s[56:57]
f_aret0:
    s_add_u32 s56, s56, f_aprog - f_aret0
    s_addc_u32 s57, s57, 0
f_ai:
    s_and_b32 s35, s23, 7
    s_add_u32 s35, s30, s35
    s_and_b32 s35, s35, 7
    s_lshl_b32 s36, s35, 7
    s_mul_i32 s37, s35, 196608
    s_add_u32 s37, s37, s54
    s_add_u32 s38, s31, s34
    s_add_u32 s31, s31, 45056
    s_cmp_eq_u32 s31, 135168
    s_cselect_b32 s31, 0, s31
    s_add_u32 s30, s30, 1
    s_mov_b32 m0, s38
    s_add_u32 s39, s36, s33
    s_bitcmp1_b32 s29, 0
    s_cbranch_scc0 f_ai0
    buffer_load_dwordx4 v8, s[4:7], s39 offen lds
f_ai0:
    s_add_u32 s36, s36, s32
    s_add_u32 m0, s38, 4096
    s_add_u32 s39, s36, 0
    buffer_load_dwordx4 v8, s[4:7], s39 offen lds
    s_add_u32 m0, s38, 8192
    s_add_u32 s39, s36, 32768
    buffer_load_dwordx4 v8, s[4:7], s39 offen lds
    s_add_u32 m0, s38, 12288
    s_add_u32 s39, s36, 65536
    buffer_load_dwordx4 v8, s[4:7], s39 offen lds
    s_add_u32 m0, s38, 16384
    s_add_u32 s39, s36, 98304
    buffer_load_dwordx4 v8, s[4:7], s39 offen lds
    s_add_u32 m0, s38, 20480
    s_add_u32 s39, s37, 0
    buffer_load_dwordx4 v9, s[8:11], s39 offen lds
    s_add_u32 m0, s38, 24576
    s_add_u32 s39, s37, 98304
    buffer_load_dwordx4 v9, s[8:11], s39 offen lds
    s_add_u32 m0, s38, 28672
    s_add_u32 s39, s37, 1024
    buffer_load_dwordx4 v9, s[8:11], s39 offen lds
    s_add_u32 m0, s38, 32768
    s_add_u32 s39, s37, 99328
    buffer_load_dwordx4 v9, s[8:11], s39 offen lds
    s_add_u32 m0, s38, 36864
    s_add_u32 s39, s37, 2048
    buffer_load_dwordx4 v9, s[8:11], s39 offen lds
    s_add_u32 m0, s38, 40960
    s_add_u32 s39, s37, 100352
    buffer_load_dwordx4 v9, s[8:11], s39 offen lds
    s_setpc_b64 s[56:57]
f_mprog:
    s_mov_b32 s12, s86
    s_and_b32 s13, s87, 0xffff
    s_mov_b32 s14, 0x01800000
    s_mov_b32 s15, 0x20000
    s_mov_b32 s51, 0
    s_add_u32 s38, s34, 114688
    s_call_b64 s[56:57], f_mx
    s_add_u32 s46, s34, 16384
    s_call_b64 s[56:57], f_mw
    s_waitcnt vmcnt(8)
    s_barrier
    s_add_u32 s46, s34, 81920
    s_call_b64 s[56:57], f_mw
    s_add_u32 s38, s34, 32768
    s_call_b64 s[56:57], f_mx
    s_add_u32 s38, s34, 131072
    s_call_b64 s[56:57], f_mx
    s_waitcnt vmcnt(12)
    s_barrier
    s_add_u32 s46, s34, 49152
    s_call_b64 s[56:57], f_mw
    s_add_u32 s38, s34, 65536
    s_call_b64 s[56:57], f_mx
    s_waitcnt vmcnt(12)
    s_barrier
    s_add_u32 s46, s34, 16384
    s_call_b64 s[56:57], f_mw
    s_add_u32 s38, s34, 98304
    s_call_b64 s[56:57], f_mx
    s_waitcnt vmcnt(12)
    s_barrier
    s_add_u32 s46, s34, 81920
    s_call_b64 s[56:57], f_mw
    s_add_u32 s38, s34, 0
    s_call_b64 s[56:57], f_mx
    s_waitcnt vmcnt(12)
    s_barrier
    s_add_u32 s46, s34, 49152
    s_call_b64 s[56:57], f_mw
    s_waitcnt vmcnt(8)
    s_barrier
    s_add_u32 s38, s34, 16384
    s_call_b64 s[56:57], f_mx
    s_waitcnt vmcnt(4)
    s_barrier
    s_add_u32 s46, s34, 81920
    s_call_b64 s[56:57], f_mw
    s_waitcnt vmcnt(0)
    s_barrier
    s_sub_u32 s33, s33, 1792
    s_barrier
    s_add_u32 s46, s34, 49152
    s_call_b64 s[56:57], f_mw
    s_add_u32 s46, s34, 81920
    s_call_b64 s[56:57], f_mw
    s_call_b64 s[56:57], f_lsetup
    v_mov_b32 v22, 0
    global_load_dwordx2 v[24:25], v22, s[84:85] sc0 sc1
    s_setprio 0
    buffer_load_dwordx4 v[64:67], v11, s[96:99], s71 offen
    s_add_u32 s39, s71, 131072
    buffer_load_dwordx4 v[68:71], v11, s[96:99], s39 offen
    s_add_u32 s39, s71, 262144
    buffer_load_dwordx4 v[72:75], v11, s[96:99], s39 offen
    s_add_u32 s39, s71, 393216
    buffer_load_dwordx4 v[76:79], v11, s[96:99], s39 offen
    s_add_u32 s71, s71, 128
    s_cmp_eq_u32 s71, s72
    s_cselect_b32 s71, s70, s71
    buffer_load_dwordx4 v[80:83], v11, s[96:99], s71 offen
    s_add_u32 s39, s71, 131072
    buffer_load_dwordx4 v[84:87], v11, s[96:99], s39 offen
    s_add_u32 s39, s71, 262144
    buffer_load_dwordx4 v[88:91], v11, s[96:99], s39 offen
    s_add_u32 s39, s71, 393216
    buffer_load_dwordx4 v[92:95], v11, s[96:99], s39 offen
    s_add_u32 s71, s71, 128
    s_cmp_eq_u32 s71, s72
    s_cselect_b32 s71, s70, s71
    s_waitcnt vmcnt(13)
    s_barrier
    s_waitcnt vmcnt(9)
    s_barrier
    s_add_u32 s46, s34, 49152
    s_call_b64 s[56:57], f_mw
    s_add_u32 s46, s34, 147456
    s_call_b64 s[56:57], f_mw
    s_waitcnt vmcnt(4)
    s_barrier
    s_add_u32 s46, s34, 81920
    s_call_b64 s[56:57], f_mw
    s_add_u32 s46, s34, 114688
    s_call_b64 s[56:57], f_mw
    s_waitcnt vmcnt(8)
    s_barrier
    s_add_u32 s46, s34, 49152
    s_call_b64 s[56:57], f_mw
    s_add_u32 s46, s34, 32768
    s_call_b64 s[56:57], f_mw
    s_waitcnt vmcnt(12)
    s_barrier
    s_add_u32 s24, s34, 131072
    v_add_u32 v49, s24, v12
    ds_write_b128 v49, v[64:67] offset:0
    ds_write_b128 v49, v[68:71] offset:4096
    ds_write_b128 v49, v[72:75] offset:8192
    ds_write_b128 v49, v[76:79] offset:12288
    s_add_u32 s24, s34, 147456
    v_add_u32 v49, s24, v12
    ds_write_b128 v49, v[80:83] offset:0
    ds_write_b128 v49, v[84:87] offset:4096
    ds_write_b128 v49, v[88:91] offset:8192
    ds_write_b128 v49, v[92:95] offset:12288
    s_waitcnt vmcnt(8)
    s_barrier
    s_add_u32 m0, s34, 65536
    s_nop 0
    buffer_load_dwordx4 v11, s[96:99], s71 offen lds
    s_add_u32 m0, s34, 69632
    s_add_u32 s39, s71, 131072
    buffer_load_dwordx4 v11, s[96:99], s39 offen lds
    s_add_u32 m0, s34, 73728
    s_add_u32 s39, s71, 262144
    buffer_load_dwordx4 v11, s[96:99], s39 offen lds
    s_add_u32 m0, s34, 77824
    s_add_u32 s39, s71, 393216
    buffer_load_dwordx4 v11, s[96:99], s39 offen lds
    s_add_u32 s71, s71, 128
    s_cmp_eq_u32 s71, s72
    s_cselect_b32 s71, s70, s71
    s_add_u32 m0, s34, 81920
    s_nop 0
    buffer_load_dwordx4 v11, s[96:99], s71 offen lds
    s_add_u32 m0, s34, 86016
    s_add_u32 s39, s71, 131072
    buffer_load_dwordx4 v11, s[96:99], s39 offen lds
    s_add_u32 m0, s34, 90112
    s_add_u32 s39, s71, 262144
    buffer_load_dwordx4 v11, s[96:99], s39 offen lds
    s_add_u32 m0, s34, 94208
    s_add_u32 s39, s71, 393216
    buffer_load_dwordx4 v11, s[96:99], s39 offen lds
    s_add_u32 s71, s71, 128
    s_cmp_eq_u32 s71, s72
    s_cselect_b32 s71, s70, s71
    s_waitcnt vmcnt(12)
    s_barrier
    s_add_u32 m0, s34, 98304
    s_nop 0
    buffer_load_dwordx4 v11, s[96:99], s71 offen lds
    s_add_u32 m0, s34, 102400
    s_add_u32 s39, s71, 131072
    buffer_load_dwordx4 v11, s[96:99], s39 offen lds
    s_add_u32 m0, s34, 106496
    s_add_u32 s39, s71, 262144
    buffer_load_dwordx4 v11, s[96:99], s39 offen lds
    s_add_u32 m0, s34, 110592
    s_add_u32 s39, s71, 393216
    buffer_load_dwordx4 v11, s[96:99], s39 offen lds
    s_add_u32 s71, s71, 128
    s_cmp_eq_u32 s71, s72
    s_cselect_b32 s71, s70, s71
    s_add_u32 m0, s34, 114688
    s_nop 0
    buffer_load_dwordx4 v11, s[96:99], s71 offen lds
    s_add_u32 m0, s34, 118784
    s_add_u32 s39, s71, 131072
    buffer_load_dwordx4 v11, s[96:99], s39 offen lds
    s_add_u32 m0, s34, 122880
    s_add_u32 s39, s71, 262144
    buffer_load_dwordx4 v11, s[96:99], s39 offen lds
    s_add_u32 m0, s34, 126976
    s_add_u32 s39, s71, 393216
    buffer_load_dwordx4 v11, s[96:99], s39 offen lds
    s_add_u32 s71, s71, 128
    s_cmp_eq_u32 s71, s72
    s_cselect_b32 s71, s70, s71
    s_waitcnt vmcnt(16)
    s_barrier
    s_waitcnt lgkmcnt(0)
    s_barrier
    s_setprio 3
    s_mov_b32 s8, s68
    s_and_b32 s9, s69, 0xffff
    s_mov_b32 s10, 0x00080000
    s_mov_b32 s11, 0x20000
    s_mov_b32 s47, 0
tag_1w:
    s_waitcnt vmcnt(0)
    v_readfirstlane_b32 s62, v24
    v_readfirstlane_b32 s63, v25
    s_add_u32 s47, s47, 1
    s_cmp_lg_u32 s62, 0
    s_cbranch_scc1 tag_1k
    global_load_dwordx2 v[24:25], v22, s[84:85] sc0 sc1
    s_cmp_lt_u32 s47, 0x40000
    s_cbranch_scc1 tag_1w
tag_1k:
    s_xor_b32 s60, s62, 2
    s_mov_b32 s61, s63
    v_mov_b32 v22, 64512
    s_cmp_lg_u32 s29, 0
    s_cbranch_scc1 wp_2o
    s_mov_b32 s47, 0
poll_3w:
    buffer_load_dwordx2 v[20:21], v16, s[12:15], 0 offen sc0 sc1
    s_add_u32 s47, s47, 1
    s_waitcnt vmcnt(0)
    v_cmp_ne_u64 vcc, s[62:63], v[20:21]
    s_cmp_gt_u32 s47, 0x40000
    s_cbranch_scc1 poll_3k
    s_cbranch_vccz poll_3k
    s_sleep 2
    s_branch poll_3w
poll_3k:
    v_mov_b32 v20, s60
    v_mov_b32 v21, s61
    ds_write_b64 v22, v[20:21]
    s_branch wp_2d
wp_2o:
    s_waitcnt vmcnt(0)
wp_2s:
    s_sleep 1
    ds_read_b64 v[20:21], v22
    s_waitcnt lgkmcnt(0)
    v_cmp_ne_u64 vcc, s[60:61], v[20:21]
    s_cbranch_vccnz wp_2s
wp_2d:
    s_add_u32 m0, s77, 0
    s_cmp_ge_u32 s29, 2
    buffer_load_dwordx4 v12, s[12:15], s76 offen offset:0 sc1 lds
    buffer_load_dwordx4 v12, s[12:15], s76 offen offset:1024 sc1 lds
    buffer_load_dwordx4 v12, s[12:15], s76 offen offset:2048 sc1 lds
    s_cbranch_scc1 l3_4
    buffer_load_dwordx4 v12, s[12:15], s76 offen offset:3072 sc1 lds
l3_4:
    s_add_u32 s76, s76, 14336
    s_cmp_eq_u32 s76, s75
    s_cselect_b32 s76, s74, s76
    s_add_u32 m0, s77, 16384
    s_cmp_ge_u32 s29, 2
    buffer_load_dwordx4 v12, s[12:15], s76 offen offset:0 sc1 lds
    buffer_load_dwordx4 v12, s[12:15], s76 offen offset:1024 sc1 lds
    buffer_load_dwordx4 v12, s[12:15], s76 offen offset:2048 sc1 lds
    s_cbranch_scc1 l3_5
    buffer_load_dwordx4 v12, s[12:15], s76 offen offset:3072 sc1 lds
l3_5:
    s_add_u32 s76, s76, 14336
    s_cmp_eq_u32 s76, s75
    s_cselect_b32 s76, s74, s76
    s_add_u32 m0, s77, 32768
    s_cmp_ge_u32 s29, 2
    buffer_load_dwordx4 v12, s[12:15], s76 offen offset:0 sc1 lds
    buffer_load_dwordx4 v12, s[12:15], s76 offen offset:1024 sc1 lds
    buffer_load_dwordx4 v12, s[12:15], s76 offen offset:2048 sc1 lds
    s_cbranch_scc1 l3_6
    buffer_load_dwordx4 v12, s[12:15], s76 offen offset:3072 sc1 lds
l3_6:
    s_add_u32 s76, s76, 14336
    s_cmp_eq_u32 s76, s75
    s_cselect_b32 s76, s74, s76
    s_setprio 3
    s_waitcnt vmcnt(6)
    s_barrier
    s_add_u32 m0, s77, 49152
    s_cmp_ge_u32 s29, 2
    buffer_load_dwordx4 v12, s[12:15], s76 offen offset:0 sc1 lds
    buffer_load_dwordx4 v12, s[12:15], s76 offen offset:1024 sc1 lds
    buffer_load_dwordx4 v12, s[12:15], s76 offen offset:2048 sc1 lds
    s_cbranch_scc1 l3_7
    buffer_load_dwordx4 v12, s[12:15], s76 offen offset:3072 sc1 lds
l3_7:
    s_add_u32 s76, s76, 14336
    s_cmp_eq_u32 s76, s75
    s_cselect_b32 s76, s74, s76
    s_waitcnt vmcnt(6)
    s_barrier
    s_add_u32 m0, s77, 0
    s_cmp_ge_u32 s29, 2
    buffer_load_dwordx4 v12, s[12:15], s76 offen offset:0 sc1 lds
    buffer_load_dwordx4 v12, s[12:15], s76 offen offset:1024 sc1 lds
    buffer_load_dwordx4 v12, s[12:15], s76 offen offset:2048 sc1 lds
    s_cbranch_scc1 l3_8
    buffer_load_dwordx4 v12, s[12:15], s76 offen offset:3072 sc1 lds
l3_8:
    s_add_u32 s76, s76, 14336
    s_cmp_eq_u32 s76, s75
    s_cselect_b32 s76, s74, s76
    s_add_u32 m0, s34, 131072
    s_nop 0
    buffer_load_dwordx4 v11, s[96:99], s71 offen lds
    s_add_u32 m0, s34, 135168
    s_add_u32 s39, s71, 131072
    buffer_load_dwordx4 v11, s[96:99], s39 offen lds
    s_add_u32 m0, s34, 139264
    s_add_u32 s39, s71, 262144
    buffer_load_dwordx4 v11, s[96:99], s39 offen lds
    s_add_u32 m0, s34, 143360
    s_add_u32 s39, s71, 393216
    buffer_load_dwordx4 v11, s[96:99], s39 offen lds
    s_add_u32 s71, s71, 128
    s_cmp_eq_u32 s71, s72
    s_cselect_b32 s71, s70, s71
    s_waitcnt vmcnt(10)
    s_barrier
    s_add_u32 m0, s77, 16384
    s_cmp_ge_u32 s29, 2
    buffer_load_dwordx4 v12, s[12:15], s76 offen offset:0 sc1 lds
    buffer_load_dwordx4 v12, s[12:15], s76 offen offset:1024 sc1 lds
    buffer_load_dwordx4 v12, s[12:15], s76 offen offset:2048 sc1 lds
    s_cbranch_scc1 l3_9
    buffer_load_dwordx4 v12, s[12:15], s76 offen offset:3072 sc1 lds
l3_9:
    s_add_u32 s76, s76, 14336
    s_cmp_eq_u32 s76, s75
    s_cselect_b32 s76, s74, s76
    s_add_u32 m0, s34, 147456
    s_nop 0
    buffer_load_dwordx4 v11, s[96:99], s71 offen lds
    s_add_u32 m0, s34, 151552
    s_add_u32 s39, s71, 131072
    buffer_load_dwordx4 v11, s[96:99], s39 offen lds
    s_add_u32 m0, s34, 155648
    s_add_u32 s39, s71, 262144
    buffer_load_dwordx4 v11, s[96:99], s39 offen lds
    s_add_u32 m0, s34, 159744
    s_add_u32 s39, s71, 393216
    buffer_load_dwordx4 v11, s[96:99], s39 offen lds
    s_add_u32 s71, s71, 128
    s_cmp_eq_u32 s71, s72
    s_cselect_b32 s71, s70, s71
    s_waitcnt vmcnt(14)
    s_barrier
    s_add_u32 m0, s77, 32768
    s_cmp_ge_u32 s29, 2
    buffer_load_dwordx4 v12, s[12:15], s76 offen offset:0 sc1 lds
    buffer_load_dwordx4 v12, s[12:15], s76 offen offset:1024 sc1 lds
    buffer_load_dwordx4 v12, s[12:15], s76 offen offset:2048 sc1 lds
    s_cbranch_scc1 l3_10
    buffer_load_dwordx4 v12, s[12:15], s76 offen offset:3072 sc1 lds
l3_10:
    s_add_u32 s76, s76, 14336
    s_cmp_eq_u32 s76, s75
    s_cselect_b32 s76, s74, s76
    s_add_u32 m0, s34, 65536
    s_nop 0
    buffer_load_dwordx4 v11, s[96:99], s71 offen lds
    s_add_u32 m0, s34, 69632
    s_add_u32 s39, s71, 131072
    buffer_load_dwordx4 v11, s[96:99], s39 offen lds
    s_add_u32 m0, s34, 73728
    s_add_u32 s39, s71, 262144
    buffer_load_dwordx4 v11, s[96:99], s39 offen lds
    s_add_u32 m0, s34, 77824
    s_add_u32 s39, s71, 393216
    buffer_load_dwordx4 v11, s[96:99], s39 offen lds
    s_add_u32 s71, s71, 128
    s_cmp_eq_u32 s71, s72
    s_cselect_b32 s71, s70, s71
    s_waitcnt vmcnt(18)
    s_barrier
    s_add_u32 m0, s77, 49152
    s_cmp_ge_u32 s29, 2
    buffer_load_dwordx4 v12, s[12:15], s76 offen offset:0 sc1 lds
    buffer_load_dwordx4 v12, s[12:15], s76 offen offset:1024 sc1 lds
    buffer_load_dwordx4 v12, s[12:15], s76 offen offset:2048 sc1 lds
    s_cbranch_scc1 l3_11
    buffer_load_dwordx4 v12, s[12:15], s76 offen offset:3072 sc1 lds
l3_11:
    s_add_u32 s76, s76, 14336
    s_cmp_eq_u32 s76, s75
    s_cselect_b32 s76, s74, s76
    s_add_u32 m0, s34, 81920
    s_nop 0
    buffer_load_dwordx4 v11, s[96:99], s71 offen lds
    s_add_u32 m0, s34, 86016
    s_add_u32 s39, s71, 131072
    buffer_load_dwordx4 v11, s[96:99], s39 offen lds
    s_add_u32 m0, s34, 90112
    s_add_u32 s39, s71, 262144
    buffer_load_dwordx4 v11, s[96:99], s39 offen lds
    s_add_u32 m0, s34, 94208
    s_add_u32 s39, s71, 393216
    buffer_load_dwordx4 v11, s[96:99], s39 offen lds
    s_add_u32 s71, s71, 128
    s_cmp_eq_u32 s71, s72
    s_cselect_b32 s71, s70, s71
    buffer_load_dwordx2 v[28:29], v18, s[12:15], 0 offen sc0 sc1
    s_waitcnt vmcnt(19)
    s_barrier
    s_add_u32 m0, s77, 0
    s_cmp_ge_u32 s29, 2
    buffer_load_dwordx4 v12, s[12:15], s76 offen offset:0 sc1 lds
    buffer_load_dwordx4 v12, s[12:15], s76 offen offset:1024 sc1 lds
    buffer_load_dwordx4 v12, s[12:15], s76 offen offset:2048 sc1 lds
    s_cbranch_scc1 l3_12
    buffer_load_dwordx4 v12, s[12:15], s76 offen offset:3072 sc1 lds
l3_12:
    s_add_u32 s76, s76, 14336
    s_cmp_eq_u32 s76, s75
    s_cselect_b32 s76, s74, s76
    s_add_u32 m0, s34, 98304
    s_nop 0
    buffer_load_dwordx4 v11, s[96:99], s71 offen lds
    s_add_u32 m0, s34, 102400
    s_add_u32 s39, s71, 131072
    buffer_load_dwordx4 v11, s[96:99], s39 offen lds
    s_add_u32 m0, s34, 106496
    s_add_u32 s39, s71, 262144
    buffer_load_dwordx4 v11, s[96:99], s39 offen lds
    s_add_u32 m0, s34, 110592
    s_add_u32 s39, s71, 393216
    buffer_load_dwordx4 v11, s[96:99], s39 offen lds
    s_add_u32 s71, s71, 128
    s_cmp_eq_u32 s71, s72
    s_cselect_b32 s71, s70, s71
    s_waitcnt vmcnt(19)
    s_barrier
    s_add_u32 m0, s77, 16384
    s_cmp_ge_u32 s29, 2
    buffer_load_dwordx4 v12, s[12:15], s76 offen offset:0 sc1 lds
    buffer_load_dwordx4 v12, s[12:15], s76 offen offset:1024 sc1 lds
    buffer_load_dwordx4 v12, s[12:15], s76 offen offset:2048 sc1 lds
    s_cbranch_scc1 l3_13
    buffer_load_dwordx4 v12, s[12:15], s76 offen offset:3072 sc1 lds
l3_13:
    s_add_u32 s76, s76, 14336
    s_cmp_eq_u32 s76, s75
    s_cselect_b32 s76, s74, s76
    s_add_u32 m0, s34, 114688
    s_nop 0
    buffer_load_dwordx4 v11, s[96:99], s71 offen lds
    s_add_u32 m0, s34, 118784
    s_add_u32 s39, s71, 131072
    buffer_load_dwordx4 v11, s[96:99], s39 offen lds
    s_add_u32 m0, s34, 122880
    s_add_u32 s39, s71, 262144
    buffer_load_dwordx4 v11, s[96:99], s39 offen lds
    s_add_u32 m0, s34, 126976
    s_add_u32 s39, s71, 393216
    buffer_load_dwordx4 v11, s[96:99], s39 offen lds
    s_add_u32 s71, s71, 128
    s_cmp_eq_u32 s71, s72
    s_cselect_b32 s71, s70, s71
    s_waitcnt vmcnt(19)
    s_barrier
    s_add_u32 m0, s77, 32768
    s_cmp_ge_u32 s29, 2
    buffer_load_dwordx4 v12, s[12:15], s76 offen offset:0 sc1 lds
    buffer_load_dwordx4 v12, s[12:15], s76 offen offset:1024 sc1 lds
    buffer_load_dwordx4 v12, s[12:15], s76 offen offset:2048 sc1 lds
    s_cbranch_scc1 l3_14
    buffer_load_dwordx4 v12, s[12:15], s76 offen offset:3072 sc1 lds
l3_14:
    s_add_u32 s76, s76, 14336
    s_cmp_eq_u32 s76, s75
    s_cselect_b32 s76, s74, s76
    s_add_u32 m0, s34, 131072
    s_nop 0
    buffer_load_dwordx4 v11, s[96:99], s71 offen lds
    s_add_u32 m0, s34, 135168
    s_add_u32 s39, s71, 131072
    buffer_load_dwordx4 v11, s[96:99], s39 offen lds
    s_add_u32 m0, s34, 139264
    s_add_u32 s39, s71, 262144
    buffer_load_dwordx4 v11, s[96:99], s39 offen lds
    s_waitcnt vmcnt(17)
    s_barrier
    s_add_u32 m0, s77, 49152
    s_cmp_ge_u32 s29, 2
    buffer_load_dwordx4 v12, s[12:15], s76 offen offset:0 sc1 lds
    buffer_load_dwordx4 v12, s[12:15], s76 offen offset:1024 sc1 lds
    buffer_load_dwordx4 v12, s[12:15], s76 offen offset:2048 sc1 lds
    s_cbranch_scc1 l3_15
    buffer_load_dwordx4 v12, s[12:15], s76 offen offset:3072 sc1 lds
l3_15:
    s_add_u32 s76, s76, 14336
    s_cmp_eq_u32 s76, s75
    s_cselect_b32 s76, s74, s76
    s_add_u32 m0, s34, 143360
    s_add_u32 s39, s71, 393216
    buffer_load_dwordx4 v11, s[96:99], s39 offen lds
    s_add_u32 s71, s71, 128
    s_cmp_eq_u32 s71, s72
    s_cselect_b32 s71, s70, s71
    s_add_u32 m0, s34, 147456
    s_nop 0
    buffer_load_dwordx4 v11, s[96:99], s71 offen lds
    s_add_u32 m0, s34, 151552
    s_add_u32 s39, s71, 131072
    buffer_load_dwordx4 v11, s[96:99], s39 offen lds
    s_waitcnt vmcnt(16)
    s_barrier
    s_add_u32 m0, s77, 0
    s_cmp_ge_u32 s29, 2
    buffer_load_dwordx4 v12, s[12:15], s76 offen offset:0 sc1 lds
    buffer_load_dwordx4 v12, s[12:15], s76 offen offset:1024 sc1 lds
    buffer_load_dwordx4 v12, s[12:15], s76 offen offset:2048 sc1 lds
    s_cbranch_scc1 l3_16
    buffer_load_dwordx4 v12, s[12:15], s76 offen offset:3072 sc1 lds
l3_16:
    s_add_u32 s76, s76, 14336
    s_cmp_eq_u32 s76, s75
    s_cselect_b32 s76, s74, s76
    s_add_u32 m0, s34, 155648
    s_add_u32 s39, s71, 262144
    buffer_load_dwordx4 v11, s[96:99], s39 offen lds
    s_add_u32 m0, s34, 159744
    s_add_u32 s39, s71, 393216
    buffer_load_dwordx4 v11, s[96:99], s39 offen lds
    s_add_u32 s71, s71, 128
    s_cmp_eq_u32 s71, s72
    s_cselect_b32 s71, s70, s71
    s_add_u32 m0, s34, 65536
    s_nop 0
    buffer_load_dwordx4 v11, s[96:99], s71 offen lds
    v_cmp_ne_u64 vcc, s[62:63], v[28:29]
    s_cbranch_vccz of_17
    s_mov_b32 s47, 0
poll_18w:
    buffer_load_dwordx2 v[28:29], v18, s[12:15], 0 offen sc0 sc1
    s_add_u32 s47, s47, 1
    s_waitcnt vmcnt(0)
    v_cmp_ne_u64 vcc, s[62:63], v[28:29]
    s_cmp_gt_u32 s47, 0x40000
    s_cbranch_scc1 poll_18k
    s_cbranch_vccz poll_18k
    s_sleep 2
    s_branch poll_18w
poll_18k:
of_17:
    s_waitcnt vmcnt(15)
    s_barrier
    s_add_u32 m0, s77, 16384
    s_cmp_ge_u32 s29, 2
    buffer_load_dwordx4 v12, s[12:15], s76 offen offset:0 sc1 lds
    buffer_load_dwordx4 v12, s[12:15], s76 offen offset:1024 sc1 lds
    buffer_load_dwordx4 v12, s[12:15], s76 offen offset:2048 sc1 lds
    s_cbranch_scc1 l3_19
    buffer_load_dwordx4 v12, s[12:15], s76 offen offset:3072 sc1 lds
l3_19:
    s_add_u32 s76, s76, 14336
    s_cmp_eq_u32 s76, s75
    s_cselect_b32 s76, s74, s76
    s_add_u32 m0, s34, 69632
    s_add_u32 s39, s71, 131072
    buffer_load_dwordx4 v11, s[96:99], s39 offen lds
    s_add_u32 m0, s34, 73728
    s_add_u32 s39, s71, 262144
    buffer_load_dwordx4 v11, s[96:99], s39 offen lds
    s_add_u32 m0, s34, 77824
    s_add_u32 s39, s71, 393216
    buffer_load_dwordx4 v11, s[96:99], s39 offen lds
    s_add_u32 s71, s71, 128
    s_cmp_eq_u32 s71, s72
    s_cselect_b32 s71, s70, s71
    s_waitcnt vmcnt(15)
    s_barrier
    s_add_u32 m0, s77, 32768
    s_cmp_ge_u32 s29, 2
    buffer_load_dwordx4 v12, s[12:15], s76 offen offset:0 sc1 lds
    buffer_load_dwordx4 v12, s[12:15], s76 offen offset:1024 sc1 lds
    buffer_load_dwordx4 v12, s[12:15], s76 offen offset:2048 sc1 lds
    s_cbranch_scc1 l3_20
    buffer_load_dwordx4 v12, s[12:15], s76 offen offset:3072 sc1 lds
l3_20:
    s_add_u32 s76, s76, 14336
    s_cmp_eq_u32 s76, s75
    s_cselect_b32 s76, s74, s76
    s_add_u32 m0, s34, 81920
    s_nop 0
    buffer_load_dwordx4 v11, s[96:99], s71 offen lds
    s_add_u32 m0, s34, 86016
    s_add_u32 s39, s71, 131072
    buffer_load_dwordx4 v11, s[96:99], s39 offen lds
    s_add_u32 m0, s34, 90112
    s_add_u32 s39, s71, 262144
    buffer_load_dwordx4 v11, s[96:99], s39 offen lds
    s_waitcnt vmcnt(15)
    s_barrier
    s_add_u32 m0, s77, 49152
    s_cmp_ge_u32 s29, 2
    buffer_load_dwordx4 v12, s[12:15], s76 offen offset:0 sc1 lds
    buffer_load_dwordx4 v12, s[12:15], s76 offen offset:1024 sc1 lds
    buffer_load_dwordx4 v12, s[12:15], s76 offen offset:2048 sc1 lds
    s_cbranch_scc1 l3_21
    buffer_load_dwordx4 v12, s[12:15], s76 offen offset:3072 sc1 lds
l3_21:
    s_add_u32 s76, s76, 14336
    s_cmp_eq_u32 s76, s75
    s_cselect_b32 s76, s74, s76
    s_add_u32 m0, s34, 94208
    s_add_u32 s39, s71, 393216
    buffer_load_dwordx4 v11, s[96:99], s39 offen lds
    s_add_u32 s71, s71, 128
    s_cmp_eq_u32 s71, s72
    s_cselect_b32 s71, s70, s71
    s_add_u32 m0, s34, 98304
    s_nop 0
    buffer_load_dwordx4 v11, s[96:99], s71 offen lds
    s_add_u32 m0, s34, 102400
    s_add_u32 s39, s71, 131072
    buffer_load_dwordx4 v11, s[96:99], s39 offen lds
    s_waitcnt vmcnt(15)
    s_barrier
    s_add_u32 m0, s77, 0
    s_cmp_ge_u32 s29, 2
    buffer_load_dwordx4 v12, s[12:15], s76 offen offset:0 sc1 lds
    buffer_load_dwordx4 v12, s[12:15], s76 offen offset:1024 sc1 lds
    buffer_load_dwordx4 v12, s[12:15], s76 offen offset:2048 sc1 lds
    s_cbranch_scc1 l3_22
    buffer_load_dwordx4 v12, s[12:15], s76 offen offset:3072 sc1 lds
l3_22:
    s_add_u32 s76, s76, 14336
    s_cmp_eq_u32 s76, s75
    s_cselect_b32 s76, s74, s76
    s_add_u32 m0, s34, 106496
    s_add_u32 s39, s71, 262144
    buffer_load_dwordx4 v11, s[96:99], s39 offen lds
    s_add_u32 m0, s34, 110592
    s_add_u32 s39, s71, 393216
    buffer_load_dwordx4 v11, s[96:99], s39 offen lds
    s_add_u32 s71, s71, 128
    s_cmp_eq_u32 s71, s72
    s_cselect_b32 s71, s70, s71
    s_add_u32 m0, s34, 114688
    s_nop 0
    buffer_load_dwordx4 v11, s[96:99], s71 offen lds
    s_waitcnt vmcnt(15)
    s_barrier
    s_add_u32 m0, s77, 16384
    s_cmp_ge_u32 s29, 2
    buffer_load_dwordx4 v12, s[12:15], s76 offen offset:0 sc1 lds
    buffer_load_dwordx4 v12, s[12:15], s76 offen offset:1024 sc1 lds
    buffer_load_dwordx4 v12, s[12:15], s76 offen offset:2048 sc1 lds
    s_cbranch_scc1 l3_23
    buffer_load_dwordx4 v12, s[12:15], s76 offen offset:3072 sc1 lds
l3_23:
    s_add_u32 s76, s76, 14336
    s_cmp_eq_u32 s76, s75
    s_cselect_b32 s76, s74, s76
    s_add_u32 m0, s34, 118784
    s_add_u32 s39, s71, 131072
    buffer_load_dwordx4 v11, s[96:99], s39 offen lds
    s_add_u32 m0, s34, 122880
    s_add_u32 s39, s71, 262144
    buffer_load_dwordx4 v11, s[96:99], s39 offen lds
    s_add_u32 m0, s34, 126976
    s_add_u32 s39, s71, 393216
    buffer_load_dwordx4 v11, s[96:99], s39 offen lds
    s_add_u32 s71, s71, 128
    s_cmp_eq_u32 s71, s72
    s_cselect_b32 s71, s70, s71
    s_waitcnt vmcnt(14)
    s_barrier
    s_waitcnt vmcnt(7)
    s_barrier
    s_waitcnt vmcnt(0)
    s_barrier
    s_barrier
    s_setprio 0
    s_barrier
    s_add_u32 s37, s43, 0
    s_and_b32 s37, s37, 7
    s_mul_i32 s37, s37, 114688
    s_add_u32 m0, s34, 0
    s_add_u32 s39, s37, 0
    buffer_load_dwordx4 v13, s[16:19], s39 offen lds
    s_add_u32 m0, s34, 4096
    s_add_u32 s39, s37, 32768
    buffer_load_dwordx4 v13, s[16:19], s39 offen lds
    s_add_u32 m0, s34, 8192
    s_add_u32 s39, s37, 65536
    buffer_load_dwordx4 v13, s[16:19], s39 offen lds
    s_cmp_ge_u32 s29, 2
    s_cbranch_scc1 x3_24
    s_add_u32 m0, s34, 12288
    s_add_u32 s39, s37, 98304
    buffer_load_dwordx4 v13, s[16:19], s39 offen lds
x3_24:
    s_add_u32 s37, s43, 1
    s_and_b32 s37, s37, 7
    s_mul_i32 s37, s37, 114688
    s_add_u32 m0, s34, 16384
    s_add_u32 s39, s37, 0
    buffer_load_dwordx4 v13, s[16:19], s39 offen lds
    s_add_u32 m0, s34, 20480
    s_add_u32 s39, s37, 32768
    buffer_load_dwordx4 v13, s[16:19], s39 offen lds
    s_add_u32 m0, s34, 24576
    s_add_u32 s39, s37, 65536
    buffer_load_dwordx4 v13, s[16:19], s39 offen lds
    s_cmp_ge_u32 s29, 2
    s_cbranch_scc1 x3_25
    s_add_u32 m0, s34, 28672
    s_add_u32 s39, s37, 98304
    buffer_load_dwordx4 v13, s[16:19], s39 offen lds
x3_25:
    s_branch f_ltail
f_aprog:
    s_mov_b32 s12, s86
    s_and_b32 s13, s87, 0xffff
    s_mov_b32 s14, 0x01800000
    s_mov_b32 s15, 0x20000
    s_call_b64 s[56:57], f_ai
    s_lshl_b32 s35, s3, 2
    s_add_u32 s35, s35, s29
    s_lshl_b32 s36, s35, 14
    v_lshlrev_b32 v36, 12, v3
    v_lshl_add_u32 v36, v2, 7, v36
    v_add_u32 v36, s36, v36
    s_mov_b32 s60, s74
    s_mov_b32 s61, s75
    s_cmp_lt_u32 s35, 64
    s_cselect_b32 s58, s68, s78
    s_cselect_b32 s59, s69, s79
    s_cselect_b32 s37, 0, 64
    s_sub_u32 s35, s35, s37
    s_min_u32 s37, s35, 111
    s_lshl_b32 s37, s37, 13
    s_cmp_lt_u32 s35, 112
    s_cselect_b32 s36, 63, 0
    v_and_b32 v39, s36, v1
    v_lshlrev_b32 v39, 7, v39
    v_add_u32 v39, s37, v39
    s_waitcnt vmcnt(10)
    s_barrier
    s_call_b64 s[56:57], f_ai
    global_load_dword v37, v36, s[60:61]
    s_waitcnt vmcnt(11)
    s_barrier
    s_call_b64 s[56:57], f_ai
    global_load_dword v40, v39, s[58:59]
    s_waitcnt vmcnt(12)
    s_barrier
    s_call_b64 s[56:57], f_ai
    s_waitcnt vmcnt(11)
    s_barrier
    s_call_b64 s[56:57], f_ai
    s_waitcnt vmcnt(10)
    s_barrier
    s_call_b64 s[56:57], f_ai
    s_waitcnt vmcnt(10)
    s_barrier
    s_call_b64 s[56:57], f_ai
    s_waitcnt vmcnt(10)
    s_barrier
    global_load_dword v38, v36, s[60:61] offset:2048
    s_call_b64 s[56:57], f_lsetup
    v_mov_b32 v22, 0
    global_load_dwordx2 v[24:25], v22, s[84:85] sc0 sc1
    s_waitcnt vmcnt(2)
    s_barrier
    s_setprio 0
    s_barrier
    s_add_u32 m0, s34, 131072
    s_nop 0
    buffer_load_dwordx4 v11, s[96:99], s71 offen lds
    s_add_u32 m0, s34, 135168
    s_add_u32 s39, s71, 131072
    buffer_load_dwordx4 v11, s[96:99], s39 offen lds
    s_add_u32 m0, s34, 139264
    s_add_u32 s39, s71, 262144
    buffer_load_dwordx4 v11, s[96:99], s39 offen lds
    s_add_u32 m0, s34, 143360
    s_add_u32 s39, s71, 393216
    buffer_load_dwordx4 v11, s[96:99], s39 offen lds
    s_add_u32 s71, s71, 128
    s_cmp_eq_u32 s71, s72
    s_cselect_b32 s71, s70, s71
    s_add_u32 m0, s34, 147456
    s_nop 0
    buffer_load_dwordx4 v11, s[96:99], s71 offen lds
    s_add_u32 m0, s34, 151552
    s_add_u32 s39, s71, 131072
    buffer_load_dwordx4 v11, s[96:99], s39 offen lds
    s_add_u32 m0, s34, 155648
    s_add_u32 s39, s71, 262144
    buffer_load_dwordx4 v11, s[96:99], s39 offen lds
    s_add_u32 m0, s34, 159744
    s_add_u32 s39, s71, 393216
    buffer_load_dwordx4 v11, s[96:99], s39 offen lds
    s_add_u32 s71, s71, 128
    s_cmp_eq_u32 s71, s72
    s_cselect_b32 s71, s70, s71
    s_add_u32 m0, s34, 65536
    s_nop 0
    buffer_load_dwordx4 v11, s[96:99], s71 offen lds
    s_add_u32 m0, s34, 69632
    s_add_u32 s39, s71, 131072
    buffer_load_dwordx4 v11, s[96:99], s39 offen lds
    s_add_u32 m0, s34, 73728
    s_add_u32 s39, s71, 262144
    buffer_load_dwordx4 v11, s[96:99], s39 offen lds
    s_add_u32 m0, s34, 77824
    s_add_u32 s39, s71, 393216
    buffer_load_dwordx4 v11, s[96:99], s39 offen lds
    s_add_u32 s71, s71, 128
    s_cmp_eq_u32 s71, s72
    s_cselect_b32 s71, s70, s71
    s_add_u32 m0, s34, 81920
    s_nop 0
    buffer_load_dwordx4 v11, s[96:99], s71 offen lds
    s_add_u32 m0, s34, 86016
    s_add_u32 s39, s71, 131072
    buffer_load_dwordx4 v11, s[96:99], s39 offen lds
    s_add_u32 m0, s34, 90112
    s_add_u32 s39, s71, 262144
    buffer_load_dwordx4 v11, s[96:99], s39 offen lds
    s_add_u32 m0, s34, 94208
    s_add_u32 s39, s71, 393216
    buffer_load_dwordx4 v11, s[96:99], s39 offen lds
    s_add_u32 s71, s71, 128
    s_cmp_eq_u32 s71, s72
    s_cselect_b32 s71, s70, s71
    s_add_u32 m0, s34, 98304
    s_nop 0
    buffer_load_dwordx4 v11, s[96:99], s71 offen lds
    s_add_u32 m0, s34, 102400
    s_add_u32 s39, s71, 131072
    buffer_load_dwordx4 v11, s[96:99], s39 offen lds
    s_add_u32 m0, s34, 106496
    s_add_u32 s39, s71, 262144
    buffer_load_dwordx4 v11, s[96:99], s39 offen lds
    s_add_u32 m0, s34, 110592
    s_add_u32 s39, s71, 393216
    buffer_load_dwordx4 v11, s[96:99], s39 offen lds
    s_add_u32 s71, s71, 128
    s_cmp_eq_u32 s71, s72
    s_cselect_b32 s71, s70, s71
    s_add_u32 m0, s34, 114688
    s_nop 0
    buffer_load_dwordx4 v11, s[96:99], s71 offen lds
    s_add_u32 m0, s34, 118784
    s_add_u32 s39, s71, 131072
    buffer_load_dwordx4 v11, s[96:99], s39 offen lds
    s_add_u32 m0, s34, 122880
    s_add_u32 s39, s71, 262144
    buffer_load_dwordx4 v11, s[96:99], s39 offen lds
    s_add_u32 m0, s34, 126976
    s_add_u32 s39, s71, 393216
    buffer_load_dwordx4 v11, s[96:99], s39 offen lds
    s_add_u32 s71, s71, 128
    s_cmp_eq_u32 s71, s72
    s_cselect_b32 s71, s70, s71
    s_setprio 3
    s_mov_b32 s8, s68
    s_and_b32 s9, s69, 0xffff
    s_mov_b32 s10, 0x00080000
    s_mov_b32 s11, 0x20000
    s_mov_b32 s47, 0
tag_26w:
    s_waitcnt vmcnt(0)
    v_readfirstlane_b32 s62, v24
    v_readfirstlane_b32 s63, v25
    s_add_u32 s47, s47, 1
    s_cmp_lg_u32 s62, 0
    s_cbranch_scc1 tag_26k
    global_load_dwordx2 v[24:25], v22, s[84:85] sc0 sc1
    s_cmp_lt_u32 s47, 0x40000
    s_cbranch_scc1 tag_26w
tag_26k:
    s_xor_b32 s60, s62, 2
    s_mov_b32 s61, s63
    v_mov_b32 v22, 64512
    s_cmp_lg_u32 s29, 0
    s_cbranch_scc1 wp_27o
    s_mov_b32 s47, 0
poll_28w:
    buffer_load_dwordx2 v[20:21], v16, s[12:15], 0 offen sc0 sc1
    s_add_u32 s47, s47, 1
    s_waitcnt vmcnt(0)
    v_cmp_ne_u64 vcc, s[62:63], v[20:21]
    s_cmp_gt_u32 s47, 0x40000
    s_cbranch_scc1 poll_28k
    s_cbranch_vccz poll_28k
    s_sleep 2
    s_branch poll_28w
poll_28k:
    v_mov_b32 v20, s60
    v_mov_b32 v21, s61
    ds_write_b64 v22, v[20:21]
    s_branch wp_27d
wp_27o:
    s_waitcnt vmcnt(0)
wp_27s:
    s_sleep 1
    ds_read_b64 v[20:21], v22
    s_waitcnt lgkmcnt(0)
    v_cmp_ne_u64 vcc, s[60:61], v[20:21]
    s_cbranch_vccnz wp_27s
wp_27d:
    s_add_u32 m0, s77, 0
    s_cmp_ge_u32 s29, 2
    buffer_load_dwordx4 v12, s[12:15], s76 offen offset:0 sc1 lds
    buffer_load_dwordx4 v12, s[12:15], s76 offen offset:1024 sc1 lds
    buffer_load_dwordx4 v12, s[12:15], s76 offen offset:2048 sc1 lds
    s_cbranch_scc1 l3_29
    buffer_load_dwordx4 v12, s[12:15], s76 offen offset:3072 sc1 lds
l3_29:
    s_add_u32 s76, s76, 14336
    s_cmp_eq_u32 s76, s75
    s_cselect_b32 s76, s74, s76
    s_add_u32 m0, s77, 16384
    s_cmp_ge_u32 s29, 2
    buffer_load_dwordx4 v12, s[12:15], s76 offen offset:0 sc1 lds
    buffer_load_dwordx4 v12, s[12:15], s76 offen offset:1024 sc1 lds
    buffer_load_dwordx4 v12, s[12:15], s76 offen offset:2048 sc1 lds
    s_cbranch_scc1 l3_30
    buffer_load_dwordx4 v12, s[12:15], s76 offen offset:3072 sc1 lds
l3_30:
    s_add_u32 s76, s76, 14336
    s_cmp_eq_u32 s76, s75
    s_cselect_b32 s76, s74, s76
    s_add_u32 m0, s77, 32768
    s_cmp_ge_u32 s29, 2
    buffer_load_dwordx4 v12, s[12:15], s76 offen offset:0 sc1 lds
    buffer_load_dwordx4 v12, s[12:15], s76 offen offset:1024 sc1 lds
    buffer_load_dwordx4 v12, s[12:15], s76 offen offset:2048 sc1 lds
    s_cbranch_scc1 l3_31
    buffer_load_dwordx4 v12, s[12:15], s76 offen offset:3072 sc1 lds
l3_31:
    s_add_u32 s76, s76, 14336
    s_cmp_eq_u32 s76, s75
    s_cselect_b32 s76, s74, s76
    s_setprio 3
    s_waitcnt vmcnt(6)
    s_barrier
    s_add_u32 m0, s77, 49152
    s_cmp_ge_u32 s29, 2
    buffer_load_dwordx4 v12, s[12:15], s76 offen offset:0 sc1 lds
    buffer_load_dwordx4 v12, s[12:15], s76 offen offset:1024 sc1 lds
    buffer_load_dwordx4 v12, s[12:15], s76 offen offset:2048 sc1 lds
    s_cbranch_scc1 l3_32
    buffer_load_dwordx4 v12, s[12:15], s76 offen offset:3072 sc1 lds
l3_32:
    s_add_u32 s76, s76, 14336
    s_cmp_eq_u32 s76, s75
    s_cselect_b32 s76, s74, s76
    s_waitcnt vmcnt(6)
    s_barrier
    s_add_u32 m0, s77, 0
    s_cmp_ge_u32 s29, 2
    buffer_load_dwordx4 v12, s[12:15], s76 offen offset:0 sc1 lds
    buffer_load_dwordx4 v12, s[12:15], s76 offen offset:1024 sc1 lds
    buffer_load_dwordx4 v12, s[12:15], s76 offen offset:2048 sc1 lds
    s_cbranch_scc1 l3_33
    buffer_load_dwordx4 v12, s[12:15], s76 offen offset:3072 sc1 lds
l3_33:
    s_add_u32 s76, s76, 14336
    s_cmp_eq_u32 s76, s75
    s_cselect_b32 s76, s74, s76
    s_add_u32 m0, s34, 131072
    s_nop 0
    buffer_load_dwordx4 v11, s[96:99], s71 offen lds
    s_add_u32 m0, s34, 135168
    s_add_u32 s39, s71, 131072
    buffer_load_dwordx4 v11, s[96:99], s39 offen lds
    s_add_u32 m0, s34, 139264
    s_add_u32 s39, s71, 262144
    buffer_load_dwordx4 v11, s[96:99], s39 offen lds
    s_add_u32 m0, s34, 143360
    s_add_u32 s39, s71, 393216
    buffer_load_dwordx4 v11, s[96:99], s39 offen lds
    s_add_u32 s71, s71, 128
    s_cmp_eq_u32 s71, s72
    s_cselect_b32 s71, s70, s71
    s_waitcnt vmcnt(10)
    s_barrier
    s_add_u32 m0, s77, 16384
    s_cmp_ge_u32 s29, 2
    buffer_load_dwordx4 v12, s[12:15], s76 offen offset:0 sc1 lds
    buffer_load_dwordx4 v12, s[12:15], s76 offen offset:1024 sc1 lds
    buffer_load_dwordx4 v12, s[12:15], s76 offen offset:2048 sc1 lds
    s_cbranch_scc1 l3_34
    buffer_load_dwordx4 v12, s[12:15], s76 offen offset:3072 sc1 lds
l3_34:
    s_add_u32 s76, s76, 14336
    s_cmp_eq_u32 s76, s75
    s_cselect_b32 s76, s74, s76
    s_add_u32 m0, s34, 147456
    s_nop 0
    buffer_load_dwordx4 v11, s[96:99], s71 offen lds
    s_add_u32 m0, s34, 151552
    s_add_u32 s39, s71, 131072
    buffer_load_dwordx4 v11, s[96:99], s39 offen lds
    s_add_u32 m0, s34, 155648
    s_add_u32 s39, s71, 262144
    buffer_load_dwordx4 v11, s[96:99], s39 offen lds
    s_add_u32 m0, s34, 159744
    s_add_u32 s39, s71, 393216
    buffer_load_dwordx4 v11, s[96:99], s39 offen lds
    s_add_u32 s71, s71, 128
    s_cmp_eq_u32 s71, s72
    s_cselect_b32 s71, s70, s71
    s_waitcnt vmcnt(14)
    s_barrier
    s_add_u32 m0, s77, 32768
    s_cmp_ge_u32 s29, 2
    buffer_load_dwordx4 v12, s[12:15], s76 offen offset:0 sc1 lds
    buffer_load_dwordx4 v12, s[12:15], s76 offen offset:1024 sc1 lds
    buffer_load_dwordx4 v12, s[12:15], s76 offen offset:2048 sc1 lds
    s_cbranch_scc1 l3_35
    buffer_load_dwordx4 v12, s[12:15], s76 offen offset:3072 sc1 lds
l3_35:
    s_add_u32 s76, s76, 14336
    s_cmp_eq_u32 s76, s75
    s_cselect_b32 s76, s74, s76
    s_add_u32 m0, s34, 65536
    s_nop 0
    buffer_load_dwordx4 v11, s[96:99], s71 offen lds
    s_add_u32 m0, s34, 69632
    s_add_u32 s39, s71, 131072
    buffer_load_dwordx4 v11, s[96:99], s39 offen lds
    s_add_u32 m0, s34, 73728
    s_add_u32 s39, s71, 262144
    buffer_load_dwordx4 v11, s[96:99], s39 offen lds
    s_waitcnt vmcnt(17)
    s_barrier
    s_add_u32 m0, s77, 49152
    s_cmp_ge_u32 s29, 2
    buffer_load_dwordx4 v12, s[12:15], s76 offen offset:0 sc1 lds
    buffer_load_dwordx4 v12, s[12:15], s76 offen offset:1024 sc1 lds
    buffer_load_dwordx4 v12, s[12:15], s76 offen offset:2048 sc1 lds
    s_cbranch_scc1 l3_36
    buffer_load_dwordx4 v12, s[12:15], s76 offen offset:3072 sc1 lds
l3_36:
    s_add_u32 s76, s76, 14336
    s_cmp_eq_u32 s76, s75
    s_cselect_b32 s76, s74, s76
    s_add_u32 m0, s34, 77824
    s_add_u32 s39, s71, 393216
    buffer_load_dwordx4 v11, s[96:99], s39 offen lds
    s_add_u32 s71, s71, 128
    s_cmp_eq_u32 s71, s72
    s_cselect_b32 s71, s70, s71
    s_add_u32 m0, s34, 81920
    s_nop 0
    buffer_load_dwordx4 v11, s[96:99], s71 offen lds
    s_add_u32 m0, s34, 86016
    s_add_u32 s39, s71, 131072
    buffer_load_dwordx4 v11, s[96:99], s39 offen lds
    buffer_load_dwordx2 v[28:29], v18, s[12:15], 0 offen sc0 sc1
    s_waitcnt vmcnt(17)
    s_barrier
    s_add_u32 m0, s77, 0
    s_cmp_ge_u32 s29, 2
    buffer_load_dwordx4 v12, s[12:15], s76 offen offset:0 sc1 lds
    buffer_load_dwordx4 v12, s[12:15], s76 offen offset:1024 sc1 lds
    buffer_load_dwordx4 v12, s[12:15], s76 offen offset:2048 sc1 lds
    s_cbranch_scc1 l3_37
    buffer_load_dwordx4 v12, s[12:15], s76 offen offset:3072 sc1 lds
l3_37:
    s_add_u32 s76, s76, 14336
    s_cmp_eq_u32 s76, s75
    s_cselect_b32 s76, s74, s76
    s_add_u32 m0, s34, 90112
    s_add_u32 s39, s71, 262144
    buffer_load_dwordx4 v11, s[96:99], s39 offen lds
    s_add_u32 m0, s34, 94208
    s_add_u32 s39, s71, 393216
    buffer_load_dwordx4 v11, s[96:99], s39 offen lds
    s_add_u32 s71, s71, 128
    s_cmp_eq_u32 s71, s72
    s_cselect_b32 s71, s70, s71
    s_add_u32 m0, s34, 98304
    s_nop 0
    buffer_load_dwordx4 v11, s[96:99], s71 offen lds
    s_waitcnt vmcnt(16)
    s_barrier
    s_add_u32 m0, s77, 16384
    s_cmp_ge_u32 s29, 2
    buffer_load_dwordx4 v12, s[12:15], s76 offen offset:0 sc1 lds
    buffer_load_dwordx4 v12, s[12:15], s76 offen offset:1024 sc1 lds
    buffer_load_dwordx4 v12, s[12:15], s76 offen offset:2048 sc1 lds
    s_cbranch_scc1 l3_38
    buffer_load_dwordx4 v12, s[12:15], s76 offen offset:3072 sc1 lds
l3_38:
    s_add_u32 s76, s76, 14336
    s_cmp_eq_u32 s76, s75
    s_cselect_b32 s76, s74, s76
    s_add_u32 m0, s34, 102400
    s_add_u32 s39, s71, 131072
    buffer_load_dwordx4 v11, s[96:99], s39 offen lds
    s_add_u32 m0, s34, 106496
    s_add_u32 s39, s71, 262144
    buffer_load_dwordx4 v11, s[96:99], s39 offen lds
    s_add_u32 m0, s34, 110592
    s_add_u32 s39, s71, 393216
    buffer_load_dwordx4 v11, s[96:99], s39 offen lds
    s_add_u32 s71, s71, 128
    s_cmp_eq_u32 s71, s72
    s_cselect_b32 s71, s70, s71
    s_waitcnt vmcnt(16)
    s_barrier
    s_add_u32 m0, s77, 32768
    s_cmp_ge_u32 s29, 2
    buffer_load_dwordx4 v12, s[12:15], s76 offen offset:0 sc1 lds
    buffer_load_dwordx4 v12, s[12:15], s76 offen offset:1024 sc1 lds
    buffer_load_dwordx4 v12, s[12:15], s76 offen offset:2048 sc1 lds
    s_cbranch_scc1 l3_39
    buffer_load_dwordx4 v12, s[12:15], s76 offen offset:3072 sc1 lds
l3_39:
    s_add_u32 s76, s76, 14336
    s_cmp_eq_u32 s76, s75
    s_cselect_b32 s76, s74, s76
    s_add_u32 m0, s34, 114688
    s_nop 0
    buffer_load_dwordx4 v11, s[96:99], s71 offen lds
    s_add_u32 m0, s34, 118784
    s_add_u32 s39, s71, 131072
    buffer_load_dwordx4 v11, s[96:99], s39 offen lds
    s_add_u32 m0, s34, 122880
    s_add_u32 s39, s71, 262144
    buffer_load_dwordx4 v11, s[96:99], s39 offen lds
    s_waitcnt vmcnt(15)
    s_barrier
    s_add_u32 m0, s77, 49152
    s_cmp_ge_u32 s29, 2
    buffer_load_dwordx4 v12, s[12:15], s76 offen offset:0 sc1 lds
    buffer_load_dwordx4 v12, s[12:15], s76 offen offset:1024 sc1 lds
    buffer_load_dwordx4 v12, s[12:15], s76 offen offset:2048 sc1 lds
    s_cbranch_scc1 l3_40
    buffer_load_dwordx4 v12, s[12:15], s76 offen offset:3072 sc1 lds
l3_40:
    s_add_u32 s76, s76, 14336
    s_cmp_eq_u32 s76, s75
    s_cselect_b32 s76, s74, s76
    s_add_u32 m0, s34, 126976
    s_add_u32 s39, s71, 393216
    buffer_load_dwordx4 v11, s[96:99], s39 offen lds
    s_add_u32 s71, s71, 128
    s_cmp_eq_u32 s71, s72
    s_cselect_b32 s71, s70, s71
    s_add_u32 m0, s34, 131072
    s_nop 0
    buffer_load_dwordx4 v11, s[96:99], s71 offen lds
    s_add_u32 m0, s34, 135168
    s_add_u32 s39, s71, 131072
    buffer_load_dwordx4 v11, s[96:99], s39 offen lds
    s_waitcnt vmcnt(15)
    s_barrier
    s_add_u32 m0, s77, 0
    s_cmp_ge_u32 s29, 2
    buffer_load_dwordx4 v12, s[12:15], s76 offen offset:0 sc1 lds
    buffer_load_dwordx4 v12, s[12:15], s76 offen offset:1024 sc1 lds
    buffer_load_dwordx4 v12, s[12:15], s76 offen offset:2048 sc1 lds
    s_cbranch_scc1 l3_41
    buffer_load_dwordx4 v12, s[12:15], s76 offen offset:3072 sc1 lds
l3_41:
    s_add_u32 s76, s76, 14336
    s_cmp_eq_u32 s76, s75
    s_cselect_b32 s76, s74, s76
    s_add_u32 m0, s34, 139264
    s_add_u32 s39, s71, 262144
    buffer_load_dwordx4 v11, s[96:99], s39 offen lds
    s_add_u32 m0, s34, 143360
    s_add_u32 s39, s71, 393216
    buffer_load_dwordx4 v11, s[96:99], s39 offen lds
    s_add_u32 s71, s71, 128
    s_cmp_eq_u32 s71, s72
    s_cselect_b32 s71, s70, s71
    s_add_u32 m0, s34, 147456
    s_nop 0
    buffer_load_dwordx4 v11, s[96:99], s71 offen lds
    v_cmp_ne_u64 vcc, s[62:63], v[28:29]
    s_cbranch_vccz of_42
    s_mov_b32 s47, 0
poll_43w:
    buffer_load_dwordx2 v[28:29], v18, s[12:15], 0 offen sc0 sc1
    s_add_u32 s47, s47, 1
    s_waitcnt vmcnt(0)
    v_cmp_ne_u64 vcc, s[62:63], v[28:29]
    s_cmp_gt_u32 s47, 0x40000
    s_cbranch_scc1 poll_43k
    s_cbranch_vccz poll_43k
    s_sleep 2
    s_branch poll_43w
poll_43k:
of_42:
    s_waitcnt vmcnt(15)
    s_barrier
    s_add_u32 m0, s77, 16384
    s_cmp_ge_u32 s29, 2
    buffer_load_dwordx4 v12, s[12:15], s76 offen offset:0 sc1 lds
    buffer_load_dwordx4 v12, s[12:15], s76 offen offset:1024 sc1 lds
    buffer_load_dwordx4 v12, s[12:15], s76 offen offset:2048 sc1 lds
    s_cbranch_scc1 l3_44
    buffer_load_dwordx4 v12, s[12:15], s76 offen offset:3072 sc1 lds
l3_44:
    s_add_u32 s76, s76, 14336
    s_cmp_eq_u32 s76, s75
    s_cselect_b32 s76, s74, s76
    s_add_u32 m0, s34, 151552
    s_add_u32 s39, s71, 131072
    buffer_load_dwordx4 v11, s[96:99], s39 offen lds
    s_add_u32 m0, s34, 155648
    s_add_u32 s39, s71, 262144
    buffer_load_dwordx4 v11, s[96:99], s39 offen lds
    s_add_u32 m0, s34, 159744
    s_add_u32 s39, s71, 393216
    buffer_load_dwordx4 v11, s[96:99], s39 offen lds
    s_add_u32 s71, s71, 128
    s_cmp_eq_u32 s71, s72
    s_cselect_b32 s71, s70, s71
    s_waitcnt vmcnt(14)
    s_barrier
    s_add_u32 s37, s43, 0
    s_and_b32 s37, s37, 7
    s_lshl_b32 s37, s37, 16
    s_add_u32 m0, s34, 65536
    s_add_u32 s39, s37, 32768
    buffer_load_dwordx4 v13, s[8:11], s37 offen lds
    s_add_u32 m0, s34, 69632
    s_nop 0
    buffer_load_dwordx4 v13, s[8:11], s39 offen lds
    s_add_u32 s37, s43, 1
    s_and_b32 s37, s37, 7
    s_lshl_b32 s37, s37, 16
    s_add_u32 m0, s34, 73728
    s_add_u32 s39, s37, 32768
    buffer_load_dwordx4 v13, s[8:11], s37 offen lds
    s_add_u32 m0, s34, 77824
    s_nop 0
    buffer_load_dwordx4 v13, s[8:11], s39 offen lds
    s_add_u32 s37, s43, 2
    s_and_b32 s37, s37, 7
    s_lshl_b32 s37, s37, 16
    s_add_u32 m0, s34, 81920
    s_add_u32 s39, s37, 32768
    buffer_load_dwordx4 v13, s[8:11], s37 offen lds
    s_add_u32 m0, s34, 86016
    s_nop 0
    buffer_load_dwordx4 v13, s[8:11], s39 offen lds
    s_add_u32 s37, s43, 3
    s_and_b32 s37, s37, 7
    s_lshl_b32 s37, s37, 16
    s_add_u32 m0, s34, 90112
    s_add_u32 s39, s37, 32768
    buffer_load_dwordx4 v13, s[8:11], s37 offen lds
    s_add_u32 m0, s34, 94208
    s_nop 0
    buffer_load_dwordx4 v13, s[8:11], s39 offen lds
    s_waitcnt vmcnt(15)
    s_barrier
    s_add_u32 s37, s43, 4
    s_and_b32 s37, s37, 7
    s_lshl_b32 s37, s37, 16
    s_add_u32 m0, s34, 98304
    s_add_u32 s39, s37, 32768
    buffer_load_dwordx4 v13, s[8:11], s37 offen lds
    s_add_u32 m0, s34, 102400
    s_nop 0
    buffer_load_dwordx4 v13, s[8:11], s39 offen lds
    s_add_u32 s37, s43, 5
    s_and_b32 s37, s37, 7
    s_lshl_b32 s37, s37, 16
    s_add_u32 m0, s34, 106496
    s_add_u32 s39, s37, 32768
    buffer_load_dwordx4 v13, s[8:11], s37 offen lds
    s_add_u32 m0, s34, 110592
    s_nop 0
    buffer_load_dwordx4 v13, s[8:11], s39 offen lds
    s_add_u32 s37, s43, 6
    s_and_b32 s37, s37, 7
    s_lshl_b32 s37, s37, 16
    s_add_u32 m0, s34, 114688
    s_add_u32 s39, s37, 32768
    buffer_load_dwordx4 v13, s[8:11], s37 offen lds
    s_add_u32 m0, s34, 118784
    s_nop 0
    buffer_load_dwordx4 v13, s[8:11], s39 offen lds
    s_add_u32 s37, s43, 7
    s_and_b32 s37, s37, 7
    s_lshl_b32 s37, s37, 16
    s_add_u32 m0, s34, 122880
    s_add_u32 s39, s37, 32768
    buffer_load_dwordx4 v13, s[8:11], s37 offen lds
    s_add_u32 m0, s34, 126976
    s_nop 0
    buffer_load_dwordx4 v13, s[8:11], s39 offen lds
    s_waitcnt vmcnt(16)
    s_barrier
    s_barrier
f_ltail:
    s_lshl_b32 s35, s34, 2
    s_setprio 0
    s_cmp_eq_u32 s27, 0
    s_cbranch_scc1 f_lx
    s_barrier
    s_add_u32 s36, s43, 0
    s_and_b32 s36, s36, 7
    s_lshl_b32 s36, s36, 12
    s_add_u32 s36, s36, s52
    s_add_u32 m0, s35, 0
    s_nop 0
    buffer_load_dwordx4 v12, s[12:15], s36 offen offset:0 sc1 lds
    buffer_load_dwordx4 v12, s[12:15], s36 offen offset:1024 sc1 lds
    buffer_load_dwordx4 v12, s[12:15], s36 offen offset:2048 sc1 lds
    buffer_load_dwordx4 v12, s[12:15], s36 offen offset:3072 sc1 lds
    s_add_u32 s36, s43, 1
    s_and_b32 s36, s36, 7
    s_lshl_b32 s36, s36, 12
    s_add_u32 s36, s36, s52
    s_add_u32 m0, s35, 16384
    s_nop 0
    buffer_load_dwordx4 v12, s[12:15], s36 offen offset:0 sc1 lds
    buffer_load_dwordx4 v12, s[12:15], s36 offen offset:1024 sc1 lds
    buffer_load_dwordx4 v12, s[12:15], s36 offen offset:2048 sc1 lds
    buffer_load_dwordx4 v12, s[12:15], s36 offen offset:3072 sc1 lds
    s_add_u32 s36, s43, 2
    s_and_b32 s36, s36, 7
    s_lshl_b32 s36, s36, 12
    s_add_u32 s36, s36, s52
    s_add_u32 m0, s35, 32768
    s_nop 0
    buffer_load_dwordx4 v12, s[12:15], s36 offen offset:0 sc1 lds
    buffer_load_dwordx4 v12, s[12:15], s36 offen offset:1024 sc1 lds
    buffer_load_dwordx4 v12, s[12:15], s36 offen offset:2048 sc1 lds
    buffer_load_dwordx4 v12, s[12:15], s36 offen offset:3072 sc1 lds
    s_waitcnt vmcnt(8)
    s_barrier
    s_add_u32 s36, s43, 3
    s_and_b32 s36, s36, 7
    s_lshl_b32 s36, s36, 12
    s_add_u32 s36, s36, s52
    s_add_u32 m0, s35, 49152
    s_nop 0
    buffer_load_dwordx4 v12, s[12:15], s36 offen offset:0 sc1 lds
    buffer_load_dwordx4 v12, s[12:15], s36 offen offset:1024 sc1 lds
    buffer_load_dwordx4 v12, s[12:15], s36 offen offset:2048 sc1 lds
    buffer_load_dwordx4 v12, s[12:15], s36 offen offset:3072 sc1 lds
    s_waitcnt vmcnt(8)
    s_barrier
    s_add_u32 s36, s43, 4
    s_and_b32 s36, s36, 7
    s_lshl_b32 s36, s36, 12
    s_add_u32 s36, s36, s52
    s_add_u32 m0, s35, 0
    s_nop 0
    buffer_load_dwordx4 v12, s[12:15], s36 offen offset:0 sc1 lds
    buffer_load_dwordx4 v12, s[12:15], s36 offen offset:1024 sc1 lds
    buffer_load_dwordx4 v12, s[12:15], s36 offen offset:2048 sc1 lds
    buffer_load_dwordx4 v12, s[12:15], s36 offen offset:3072 sc1 lds
    s_add_u32 s37, s43, 4
    s_and_b32 s37, s37, 7
    s_mul_i32 s37, s37, 114688
    s_add_u32 m0, s34, 131072
    s_add_u32 s39, s37, 0
    buffer_load_dwordx4 v13, s[16:19], s39 offen lds
    s_add_u32 m0, s34, 135168
    s_add_u32 s39, s37, 32768
    buffer_load_dwordx4 v13, s[16:19], s39 offen lds
    s_add_u32 m0, s34, 139264
    s_add_u32 s39, s37, 65536
    buffer_load_dwordx4 v13, s[16:19], s39 offen lds
    s_cmp_ge_u32 s29, 2
    s_cbranch_scc1 x3_45
    s_add_u32 m0, s34, 143360
    s_add_u32 s39, s37, 98304
    buffer_load_dwordx4 v13, s[16:19], s39 offen lds
x3_45:
    s_waitcnt vmcnt(11)
    s_barrier
    s_add_u32 s36, s43, 5
    s_and_b32 s36, s36, 7
    s_lshl_b32 s36, s36, 12
    s_add_u32 s36, s36, s52
    s_add_u32 m0, s35, 16384
    s_nop 0
    buffer_load_dwordx4 v12, s[12:15], s36 offen offset:0 sc1 lds
    buffer_load_dwordx4 v12, s[12:15], s36 offen offset:1024 sc1 lds
    buffer_load_dwordx4 v12, s[12:15], s36 offen offset:2048 sc1 lds
    buffer_load_dwordx4 v12, s[12:15], s36 offen offset:3072 sc1 lds
    s_waitcnt vmcnt(11)
    s_barrier
    s_add_u32 s36, s43, 6
    s_and_b32 s36, s36, 7
    s_lshl_b32 s36, s36, 12
    s_add_u32 s36, s36, s52
    s_add_u32 m0, s35, 32768
    s_nop 0
    buffer_load_dwordx4 v12, s[12:15], s36 offen offset:0 sc1 lds
    buffer_load_dwordx4 v12, s[12:15], s36 offen offset:1024 sc1 lds
    buffer_load_dwordx4 v12, s[12:15], s36 offen offset:2048 sc1 lds
    buffer_load_dwordx4 v12, s[12:15], s36 offen offset:3072 sc1 lds
    s_add_u32 s37, s43, 5
    s_and_b32 s37, s37, 7
    s_mul_i32 s37, s37, 114688
    s_add_u32 m0, s34, 147456
    s_add_u32 s39, s37, 0
    buffer_load_dwordx4 v13, s[16:19], s39 offen lds
    s_add_u32 m0, s34, 151552
    s_add_u32 s39, s37, 32768
    buffer_load_dwordx4 v13, s[16:19], s39 offen lds
    s_add_u32 m0, s34, 155648
    s_add_u32 s39, s37, 65536
    buffer_load_dwordx4 v13, s[16:19], s39 offen lds
    s_cmp_ge_u32 s29, 2
    s_cbranch_scc1 x3_46
    s_add_u32 m0, s34, 159744
    s_add_u32 s39, s37, 98304
    buffer_load_dwordx4 v13, s[16:19], s39 offen lds
x3_46:
    s_waitcnt vmcnt(14)
    s_barrier
    s_add_u32 s36, s43, 7
    s_and_b32 s36, s36, 7
    s_lshl_b32 s36, s36, 12
    s_add_u32 s36, s36, s52
    s_add_u32 m0, s35, 49152
    s_nop 0
    buffer_load_dwordx4 v12, s[12:15], s36 offen offset:0 sc1 lds
    buffer_load_dwordx4 v12, s[12:15], s36 offen offset:1024 sc1 lds
    buffer_load_dwordx4 v12, s[12:15], s36 offen offset:2048 sc1 lds
    buffer_load_dwordx4 v12, s[12:15], s36 offen offset:3072 sc1 lds
    s_add_u32 s37, s43, 6
    s_and_b32 s37, s37, 7
    s_mul_i32 s37, s37, 114688
    s_add_u32 m0, s34, 65536
    s_add_u32 s39, s37, 0
    buffer_load_dwordx4 v13, s[16:19], s39 offen lds
    s_add_u32 m0, s34, 69632
    s_add_u32 s39, s37, 32768
    buffer_load_dwordx4 v13, s[16:19], s39 offen lds
    s_add_u32 m0, s34, 73728
    s_add_u32 s39, s37, 65536
    buffer_load_dwordx4 v13, s[16:19], s39 offen lds
    s_cmp_ge_u32 s29, 2
    s_cbranch_scc1 x3_47
    s_add_u32 m0, s34, 77824
    s_add_u32 s39, s37, 98304
    buffer_load_dwordx4 v13, s[16:19], s39 offen lds
x3_47:
    s_waitcnt vmcnt(14)
    s_barrier
    s_add_u32 s37, s43, 7
    s_and_b32 s37, s37, 7
    s_mul_i32 s37, s37, 114688
    s_add_u32 m0, s34, 81920
    s_add_u32 s39, s37, 0
    buffer_load_dwordx4 v13, s[16:19], s39 offen lds
    s_add_u32 m0, s34, 86016
    s_add_u32 s39, s37, 32768
    buffer_load_dwordx4 v13, s[16:19], s39 offen lds
    s_add_u32 m0, s34, 90112
    s_add_u32 s39, s37, 65536
    buffer_load_dwordx4 v13, s[16:19], s39 offen lds
    s_cmp_ge_u32 s29, 2
    s_cbranch_scc1 x3_48
    s_add_u32 m0, s34, 94208
    s_add_u32 s39, s37, 98304
    buffer_load_dwordx4 v13, s[16:19], s39 offen lds
x3_48:
    s_add_u32 s37, s43, 0
    s_and_b32 s37, s37, 7
    s_mul_i32 s37, s37, 114688
    s_add_u32 m0, s34, 0
    s_add_u32 s39, s37, 0
    buffer_load_dwordx4 v13, s[16:19], s39 offen lds
    s_add_u32 m0, s34, 4096
    s_add_u32 s39, s37, 32768
    buffer_load_dwordx4 v13, s[16:19], s39 offen lds
    s_add_u32 m0, s34, 8192
    s_add_u32 s39, s37, 65536
    buffer_load_dwordx4 v13, s[16:19], s39 offen lds
    s_cmp_ge_u32 s29, 2
    s_cbranch_scc1 x3_49
    s_add_u32 m0, s34, 12288
    s_add_u32 s39, s37, 98304
    buffer_load_dwordx4 v13, s[16:19], s39 offen lds
x3_49:
    s_waitcnt vmcnt(16)
    s_barrier
    s_add_u32 s37, s43, 1
    s_and_b32 s37, s37, 7
    s_mul_i32 s37, s37, 114688
    s_add_u32 m0, s34, 16384
    s_add_u32 s39, s37, 0
    buffer_load_dwordx4 v13, s[16:19], s39 offen lds
    s_add_u32 m0, s34, 20480
    s_add_u32 s39, s37, 32768
    buffer_load_dwordx4 v13, s[16:19], s39 offen lds
    s_add_u32 m0, s34, 24576
    s_add_u32 s39, s37, 65536
    buffer_load_dwordx4 v13, s[16:19], s39 offen lds
    s_cmp_ge_u32 s29, 2
    s_cbranch_scc1 x3_50
    s_add_u32 m0, s34, 28672
    s_add_u32 s39, s37, 98304
    buffer_load_dwordx4 v13, s[16:19], s39 offen lds
x3_50:
    s_waitcnt vmcnt(12)
    s_barrier
    s_add_u32 s37, s43, 2
    s_and_b32 s37, s37, 7
    s_mul_i32 s37, s37, 114688
    s_add_u32 m0, s34, 32768
    s_add_u32 s39, s37, 0
    buffer_load_dwordx4 v13, s[16:19], s39 offen lds
    s_add_u32 m0, s34, 36864
    s_add_u32 s39, s37, 32768
    buffer_load_dwordx4 v13, s[16:19], s39 offen lds
    s_add_u32 m0, s34, 40960
    s_add_u32 s39, s37, 65536
    buffer_load_dwordx4 v13, s[16:19], s39 offen lds
    s_cmp_ge_u32 s29, 2
    s_cbranch_scc1 x3_51
    s_add_u32 m0, s34, 45056
    s_add_u32 s39, s37, 98304
    buffer_load_dwordx4 v13, s[16:19], s39 offen lds
x3_51:
    s_barrier
    s_add_u32 s37, s43, 3
    s_and_b32 s37, s37, 7
    s_mul_i32 s37, s37, 114688
    s_add_u32 m0, s34, 49152
    s_add_u32 s39, s37, 0
    buffer_load_dwordx4 v13, s[16:19], s39 offen lds
    s_add_u32 m0, s34, 53248
    s_add_u32 s39, s37, 32768
    buffer_load_dwordx4 v13, s[16:19], s39 offen lds
    s_add_u32 m0, s34, 57344
    s_add_u32 s39, s37, 65536
    buffer_load_dwordx4 v13, s[16:19], s39 offen lds
    s_cmp_ge_u32 s29, 2
    s_cbranch_scc1 x3_52
    s_add_u32 m0, s34, 61440
    s_add_u32 s39, s37, 98304
    buffer_load_dwordx4 v13, s[16:19], s39 offen lds
x3_52:
    s_waitcnt vmcnt(0)
    s_barrier
    s_branch f_lx2
f_lx:
    s_barrier
    s_add_u32 s37, s43, 2
    s_and_b32 s37, s37, 7
    s_mul_i32 s37, s37, 114688
    s_add_u32 m0, s34, 32768
    s_add_u32 s39, s37, 0
    buffer_load_dwordx4 v13, s[16:19], s39 offen lds
    s_add_u32 m0, s34, 36864
    s_add_u32 s39, s37, 32768
    buffer_load_dwordx4 v13, s[16:19], s39 offen lds
    s_add_u32 m0, s34, 40960
    s_add_u32 s39, s37, 65536
    buffer_load_dwordx4 v13, s[16:19], s39 offen lds
    s_cmp_ge_u32 s29, 2
    s_cbranch_scc1 x3_53
    s_add_u32 m0, s34, 45056
    s_add_u32 s39, s37, 98304
    buffer_load_dwordx4 v13, s[16:19], s39 offen lds
x3_53:
    s_add_u32 s37, s43, 3
    s_and_b32 s37, s37, 7
    s_mul_i32 s37, s37, 114688
    s_add_u32 m0, s34, 49152
    s_add_u32 s39, s37, 0
    buffer_load_dwordx4 v13, s[16:19], s39 offen lds
    s_add_u32 m0, s34, 53248
    s_add_u32 s39, s37, 32768
    buffer_load_dwordx4 v13, s[16:19], s39 offen lds
    s_add_u32 m0, s34, 57344
    s_add_u32 s39, s37, 65536
    buffer_load_dwordx4 v13, s[16:19], s39 offen lds
    s_cmp_ge_u32 s29, 2
    s_cbranch_scc1 x3_54
    s_add_u32 m0, s34, 61440
    s_add_u32 s39, s37, 98304
    buffer_load_dwordx4 v13, s[16:19], s39 offen lds
x3_54:
    s_add_u32 s37, s43, 4
    s_and_b32 s37, s37, 7
    s_mul_i32 s37, s37, 114688
    s_add_u32 m0, s34, 131072
    s_add_u32 s39, s37, 0
    buffer_load_dwordx4 v13, s[16:19], s39 offen lds
    s_add_u32 m0, s34, 135168
    s_add_u32 s39, s37, 32768
    buffer_load_dwordx4 v13, s[16:19], s39 offen lds
    s_add_u32 m0, s34, 139264
    s_add_u32 s39, s37, 65536
    buffer_load_dwordx4 v13, s[16:19], s39 offen lds
    s_cmp_ge_u32 s29, 2
    s_cbranch_scc1 x3_55
    s_add_u32 m0, s34, 143360
    s_add_u32 s39, s37, 98304
    buffer_load_dwordx4 v13, s[16:19], s39 offen lds
x3_55:
    s_add_u32 s37, s43, 5
    s_and_b32 s37, s37, 7
    s_mul_i32 s37, s37, 114688
    s_add_u32 m0, s34, 147456
    s_add_u32 s39, s37, 0
    buffer_load_dwordx4 v13, s[16:19], s39 offen lds
    s_add_u32 m0, s34, 151552
    s_add_u32 s39, s37, 32768
    buffer_load_dwordx4 v13, s[16:19], s39 offen lds
    s_add_u32 m0, s34, 155648
    s_add_u32 s39, s37, 65536
    buffer_load_dwordx4 v13, s[16:19], s39 offen lds
    s_cmp_ge_u32 s29, 2
    s_cbranch_scc1 x3_56
    s_add_u32 m0, s34, 159744
    s_add_u32 s39, s37, 98304
    buffer_load_dwordx4 v13, s[16:19], s39 offen lds
x3_56:
    s_add_u32 s37, s43, 6
    s_and_b32 s37, s37, 7
    s_mul_i32 s37, s37, 114688
    s_add_u32 m0, s34, 65536
    s_add_u32 s39, s37, 0
    buffer_load_dwordx4 v13, s[16:19], s39 offen lds
    s_add_u32 m0, s34, 69632
    s_add_u32 s39, s37, 32768
    buffer_load_dwordx4 v13, s[16:19], s39 offen lds
    s_add_u32 m0, s34, 73728
    s_add_u32 s39, s37, 65536
    buffer_load_dwordx4 v13, s[16:19], s39 offen lds
    s_cmp_ge_u32 s29, 2
    s_cbranch_scc1 x3_57
    s_add_u32 m0, s34, 77824
    s_add_u32 s39, s37, 98304
    buffer_load_dwordx4 v13, s[16:19], s39 offen lds
x3_57:
    s_add_u32 s37, s43, 7
    s_and_b32 s37, s37, 7
    s_mul_i32 s37, s37, 114688
    s_add_u32 m0, s34, 81920
    s_add_u32 s39, s37, 0
    buffer_load_dwordx4 v13, s[16:19], s39 offen lds
    s_add_u32 m0, s34, 86016
    s_add_u32 s39, s37, 32768
    buffer_load_dwordx4 v13, s[16:19], s39 offen lds
    s_add_u32 m0, s34, 90112
    s_add_u32 s39, s37, 65536
    buffer_load_dwordx4 v13, s[16:19], s39 offen lds
    s_cmp_ge_u32 s29, 2
    s_cbranch_scc1 x3_58
    s_add_u32 m0, s34, 94208
    s_add_u32 s39, s37, 98304
    buffer_load_dwordx4 v13, s[16:19], s39 offen lds
x3_58:
    s_waitcnt vmcnt(12)
    s_barrier
f_lx2:
    s_barrier
    s_setprio 3
    s_xor_b32 s60, s62, 4
    s_mov_b32 s61, s63
    v_mov_b32 v22, 64512
    s_cmp_lg_u32 s29, 0
    s_cbranch_scc1 wp_59o
    s_mov_b32 s47, 0
poll_60w:
    buffer_load_dwordx2 v[20:21], v17, s[12:15], 0 offen sc0 sc1
    s_add_u32 s47, s47, 1
    s_waitcnt vmcnt(0)
    v_cmp_ne_u64 vcc, s[62:63], v[20:21]
    s_cmp_gt_u32 s47, 0x40000
    s_cbranch_scc1 poll_60k
    s_cbranch_vccz poll_60k
    s_sleep 2
    s_branch poll_60w
poll_60k:
    v_mov_b32 v20, s60
    v_mov_b32 v21, s61
    ds_write_b64 v22, v[20:21]
    s_branch wp_59d
wp_59o:
    s_waitcnt vmcnt(0)
wp_59s:
    s_sleep 1
    ds_read_b64 v[20:21], v22
    s_waitcnt lgkmcnt(0)
    v_cmp_ne_u64 vcc, s[60:61], v[20:21]
    s_cbranch_vccnz wp_59s
wp_59d:
    s_mul_i32 s37, s55, 14336
    s_add_u32 s37, s37, s53
    s_add_u32 s55, s55, 1
    s_and_b32 s55, s55, 7
    s_add_u32 m0, s77, 0
    s_cmp_ge_u32 s29, 2
    buffer_load_dwordx4 v12, s[12:15], s37 offen offset:0 sc1 lds
    buffer_load_dwordx4 v12, s[12:15], s37 offen offset:1024 sc1 lds
    buffer_load_dwordx4 v12, s[12:15], s37 offen offset:2048 sc1 lds
    s_cbranch_scc1 l3_61
    buffer_load_dwordx4 v12, s[12:15], s37 offen offset:3072 sc1 lds
l3_61:
    s_mul_i32 s37, s55, 14336
    s_add_u32 s37, s37, s53
    s_add_u32 s55, s55, 1
    s_and_b32 s55, s55, 7
    s_add_u32 m0, s77, 16384
    s_cmp_ge_u32 s29, 2
    buffer_load_dwordx4 v12, s[12:15], s37 offen offset:0 sc1 lds
    buffer_load_dwordx4 v12, s[12:15], s37 offen offset:1024 sc1 lds
    buffer_load_dwordx4 v12, s[12:15], s37 offen offset:2048 sc1 lds
    s_cbranch_scc1 l3_62
    buffer_load_dwordx4 v12, s[12:15], s37 offen offset:3072 sc1 lds
l3_62:
    s_mul_i32 s37, s55, 14336
    s_add_u32 s37, s37, s53
    s_add_u32 s55, s55, 1
    s_and_b32 s55, s55, 7
    s_add_u32 m0, s77, 32768
    s_cmp_ge_u32 s29, 2
    buffer_load_dwordx4 v12, s[12:15], s37 offen offset:0 sc1 lds
    buffer_load_dwordx4 v12, s[12:15], s37 offen offset:1024 sc1 lds
    buffer_load_dwordx4 v12, s[12:15], s37 offen offset:2048 sc1 lds
    s_cbranch_scc1 l3_63
    buffer_load_dwordx4 v12, s[12:15], s37 offen offset:3072 sc1 lds
l3_63:
    s_mul_i32 s37, s55, 14336
    s_add_u32 s37, s37, s53
    s_add_u32 s55, s55, 1
    s_and_b32 s55, s55, 7
    s_add_u32 m0, s77, 49152
    s_cmp_ge_u32 s29, 2
    buffer_load_dwordx4 v12, s[12:15], s37 offen offset:0 sc1 lds
    buffer_load_dwordx4 v12, s[12:15], s37 offen offset:1024 sc1 lds
    buffer_load_dwordx4 v12, s[12:15], s37 offen offset:2048 sc1 lds
    s_cbranch_scc1 l3_64
    buffer_load_dwordx4 v12, s[12:15], s37 offen offset:3072 sc1 lds
l3_64:
    s_waitcnt vmcnt(9)
    s_barrier
    s_waitcnt vmcnt(6)
    s_barrier
    s_mul_i32 s37, s55, 14336
    s_add_u32 s37, s37, s53
    s_add_u32 s55, s55, 1
    s_and_b32 s55, s55, 7
    s_add_u32 m0, s77, 0
    s_cmp_ge_u32 s29, 2
    buffer_load_dwordx4 v12, s[12:15], s37 offen offset:0 sc1 lds
    buffer_load_dwordx4 v12, s[12:15], s37 offen offset:1024 sc1 lds
    buffer_load_dwordx4 v12, s[12:15], s37 offen offset:2048 sc1 lds
    s_cbranch_scc1 l3_65
    buffer_load_dwordx4 v12, s[12:15], s37 offen offset:3072 sc1 lds
l3_65:
    s_waitcnt vmcnt(6)
    s_barrier
    s_mul_i32 s37, s55, 14336
    s_add_u32 s37, s37, s53
    s_add_u32 s55, s55, 1
    s_and_b32 s55, s55, 7
    s_add_u32 m0, s77, 16384
    s_cmp_ge_u32 s29, 2
    buffer_load_dwordx4 v12, s[12:15], s37 offen offset:0 sc1 lds
    buffer_load_dwordx4 v12, s[12:15], s37 offen offset:1024 sc1 lds
    buffer_load_dwordx4 v12, s[12:15], s37 offen offset:2048 sc1 lds
    s_cbranch_scc1 l3_66
    buffer_load_dwordx4 v12, s[12:15], s37 offen offset:3072 sc1 lds
l3_66:
    s_waitcnt vmcnt(6)
    s_barrier
    s_mul_i32 s37, s55, 14336
    s_add_u32 s37, s37, s53
    s_add_u32 s55, s55, 1
    s_and_b32 s55, s55, 7
    s_add_u32 m0, s77, 32768
    s_cmp_ge_u32 s29, 2
    buffer_load_dwordx4 v12, s[12:15], s37 offen offset:0 sc1 lds
    buffer_load_dwordx4 v12, s[12:15], s37 offen offset:1024 sc1 lds
    buffer_load_dwordx4 v12, s[12:15], s37 offen offset:2048 sc1 lds
    s_cbranch_scc1 l3_67
    buffer_load_dwordx4 v12, s[12:15], s37 offen offset:3072 sc1 lds
l3_67:
    s_waitcnt vmcnt(6)
    s_barrier
    s_mul_i32 s37, s55, 14336
    s_add_u32 s37, s37, s53
    s_add_u32 s55, s55, 1
    s_and_b32 s55, s55, 7
    s_add_u32 m0, s77, 49152
    s_cmp_ge_u32 s29, 2
    buffer_load_dwordx4 v12, s[12:15], s37 offen offset:0 sc1 lds
    buffer_load_dwordx4 v12, s[12:15], s37 offen offset:1024 sc1 lds
    buffer_load_dwordx4 v12, s[12:15], s37 offen offset:2048 sc1 lds
    s_cbranch_scc1 l3_68
    buffer_load_dwordx4 v12, s[12:15], s37 offen offset:3072 sc1 lds
l3_68:
    s_waitcnt vmcnt(6)
    s_barrier
    s_waitcnt vmcnt(3)
    s_barrier
    s_waitcnt vmcnt(0)
    s_barrier
    s_endpgm
f_lsetup:
    s_mov_b32 s96, s74
    s_and_b32 s97, s75, 0xffff
    s_mov_b32 s98, 0x00800000
    s_mov_b32 s99, 0x20000
    s_mov_b32 s16, s78
    s_and_b32 s17, s79, 0xffff
    s_mov_b32 s18, 0x000e0000
    s_mov_b32 s19, 0x20000
    s_and_b32 s24, s29, 1
    s_lshr_b32 s25, s29, 1
    s_lshl_b32 s26, s24, 4
    s_add_u32 s26, s26, s25
    v_lshrrev_b32 v6, 3, v1
    v_lshlrev_b32 v6, 1, v6
    v_add_u32 v6, s26, v6
    v_lshlrev_b32 v6, 12, v6
    s_lshl_b32 s24, s24, 2
    v_lshrrev_b32 v7, 4, v1
    v_add_u32 v7, s24, v7
    v_and_b32 v11, 7, v1
    v_xor_b32 v11, v11, v7
    v_lshl_add_u32 v11, v11, 4, v6
    v_lshlrev_b32 v12, 4, v1
    s_cmp_eq_u32 s27, 0
    s_cselect_b32 s24, 0, 18
    s_cselect_b32 s25, 18, 14
    s_and_b32 s26, s23, 7
    s_mul_i32 s26, s26, s25
    s_lshr_b32 s26, s26, 3
    s_lshl_b32 s70, s21, 19
    s_lshl_b32 s50, s24, 7
    s_add_u32 s70, s70, s50
    s_lshl_b32 s50, s25, 7
    s_add_u32 s72, s70, s50
    s_lshl_b32 s50, s26, 7
    s_add_u32 s71, s70, s50
    s_lshl_b32 s77, s29, 12
    s_cmp_eq_u32 s29, 3
    s_cselect_b32 s77, 11264, s77
    s_lshl_b32 s74, s22, 5
    s_add_u32 s74, s74, s24
    s_mul_i32 s74, s74, 14336
    s_add_u32 s74, s74, s77
    s_add_u32 s74, s74, 524288
    s_mul_i32 s50, s25, 14336
    s_add_u32 s75, s74, s50
    s_mul_i32 s50, s26, 14336
    s_add_u32 s76, s74, s50
    s_lshl_b32 s25, s25, 1
    s_sub_u32 s25, s25, 1
    v_min_u32 v16, s25, v1
    s_lshl_b32 s50, s22, 6
    s_lshl_b32 s24, s24, 1
    s_add_u32 s50, s50, s24
    s_lshl_b32 s50, s50, 3
    s_add_u32 s50, s50, 262144
    v_lshlrev_b32 v16, 3, v16
    v_add_u32 v16, s50, v16
    s_lshr_b32 s24, s29, 1
    s_lshl_b32 s24, s24, 2
    s_sub_u32 s52, s44, s24
    s_lshl_b32 s52, s52, 1
    s_and_b32 s24, s29, 1
    s_add_u32 s52, s52, s24
    s_lshl_b32 s52, s52, 15
    s_add_u32 s52, s52, 4194304
    s_mul_i32 s53, s44, 114688
    s_add_u32 s53, s53, s77
    s_add_u32 s53, s53, 6291456
    s_and_b32 s24, s44, 3
    s_lshl_b32 s24, s24, 1
    s_add_u32 s43, s45, s24
    s_and_b32 s43, s43, 7
    s_mov_b32 s42, s43
    s_mov_b32 s55, s43
    v_lshrrev_b32 v7, 3, v1
    s_lshl_b32 s24, s29, 3
    v_add_u32 v13, s24, v7
    v_lshlrev_b32 v13, 10, v13
    v_bfe_u32 v5, v1, 1, 2
    v_xor_b32 v6, v3, v5
    v_and_b32 v4, 1, v1
    v_lshl_or_b32 v6, v6, 1, v4
    v_lshl_add_u32 v13, v6, 4, v13
    s_lshl_b32 s25, s45, 7
    v_add_u32 v13, s25, v13
    v_lshlrev_b32 v6, 3, v2
    s_lshl_b32 s24, s44, 7
    s_add_u32 s24, s24, 274432
    v_add_u32 v17, s24, v6
    v_and_b32 v6, 31, v1
    v_lshlrev_b32 v6, 3, v6
    s_lshr_b32 s24, s44, 1
    s_lshl_b32 s24, s24, 8
    s_add_u32 s24, s24, 270336
    v_add_u32 v18, s24, v6
    s_lshl_b32 s24, s27, 9
    s_mul_i32 s24, s24, 1
    v_subrev_u32 v7, s24, v18
    v_cmp_gt_u32 vcc, 32, v1
    s_nop 1
    v_cndmask_b32 v18, v7, v18, vcc
    s_lshl_b32 s24, s3, 5
    s_add_u32 s24, s24, 278528
    s_lshl_b32 s41, s21, 3
    s_add_u32 s41, s41, s22
    s_lshl_b32 s24, s41, 5
    s_add_u32 s24, s24, 266240
    v_and_b32 v6, 24, v6
    v_add_u32 v19, s24, v6
    s_lshr_b32 s24, s2, 4
    s_lshl_b32 s24, s24, 2
    s_add_u32 s24, s24, s29
    s_mul_i32 s25, s24, 14336
    v_lshlrev_b32 v26, 7, v1
    v_add_u32 v26, s25, v26
    s_lshl_b32 s24, s24, 15
    s_lshr_b32 s25, s21, 2
    s_lshl_b32 s25, s25, 21
    s_add_u32 s24, s24, s25
    v_lshlrev_b32 v27, 12, v3
    v_lshl_add_u32 v27, v2, 7, v27
    v_add_u32 v27, s24, v27
    v_bfe_u32 v33, v1, 2, 3
    v_lshlrev_b32 v33, 12, v33
    v_and_b32 v7, 3, v1
    v_lshl_add_u32 v33, v7, 7, v33
    v_add_u32 v33, s24, v33
    s_getpc_b64 s[88:89]
f_lsp:
    s_sub_u32 s88, s88, f_lsp - gated_mix__sliding_local_dilated__mixer_gmlp__prompt_kernel
    s_subb_u32 s89, s89, 0
    s_lshr_b32 s24, s2, 3
    s_lshl_b32 s24, s24, 2
    s_add_u32 s24, s24, s29
    s_mul_i32 s24, s24, 384
    v_min_u32 v34, 2, v1
    v_lshlrev_b32 v34, 7, v34
    v_add_u32 v34, s24, v34
    v_min_u32 v34, 0x00007e78, v34
    s_mul_i32 s41, s41, 28672
    s_add_u32 s41, s41, s77
    s_add_u32 s41, s41, 13107200
    s_setpc_b64 s[56:57]
f_comp:
    s_cmp_lg_u32 s20, 3
    s_cbranch_scc1 cpf_69
    s_getpc_b64 s[58:59]
cpf_69p:
    s_sub_u32 s58, s58, cpf_69p - gated_mix__sliding_local_dilated__mixer_gmlp__prompt_kernel
    s_subb_u32 s59, s59, 0
    s_lshr_b32 s24, s2, 3
    s_mul_i32 s24, s24, 1536
    v_lshlrev_b32 v250, 7, v1
    v_add_u32 v250, s24, v250
    v_min_u32 v250, 0x00007e78, v250
    s_mov_b64 exec, 0xfff
    global_load_dword v250, v250, s[58:59]
    s_mov_b64 exec, -1
cpf_69:
    s_waitcnt lgkmcnt(0)
    s_mov_b32 s4, s64
    s_mov_b32 s5, s65
    s_mov_b32 s12, s86
    s_and_b32 s13, s87, 0xffff
    s_mov_b32 s14, 0x01800000
    s_mov_b32 s15, 0x20000
    s_cmp_eq_u32 s27, 1
    s_cbranch_scc1 f_attn
    s_lshl_b32 s24, s21, 2
    s_add_u32 s24, s24, s29
    s_lshl_b32 s24, s24, 6
    v_lshlrev_b32 v7, 2, v2
    v_add_u32 v7, s24, v7
    global_load_dword v251, v7, s[76:77]
    v_lshrrev_b32 v7, 1, v2
    v_xor_b32 v7, v7, v3
    v_lshlrev_b32 v7, 4, v7
    v_lshl_add_u32 v5, v2, 7, v7
    v_xor_b32 v6, 64, v5
    s_lshl_b32 s24, s29, 12
    v_add_u32 v5, s24, v5
    v_add_u32 v6, s24, v6
    v_lshrrev_b32 v7, 2, v2
    v_lshl_add_u32 v18, v3, 3, v7
    v_lshlrev_b32 v18, 7, v18
    v_and_b32 v19, 3, v2
    v_lshl_add_u32 v18, v19, 3, v18
    v_add_u32 v18, 0, v18
    v_lshrrev_b32 v7, 3, v2
    v_and_b32 v19, 1, v3
    v_lshl_or_b32 v7, v19, 1, v7
    v_lshl_add_u32 v8, v7, 5, v18
    v_xor_b32 v9, 32, v8
    v_xor_b32 v10, 64, v8
    v_xor_b32 v11, 96, v8
    v_pk_mov_b32 v[20:21], 0, 0
    v_pk_mov_b32 v[22:23], 0, 0
    v_pk_mov_b32 v[24:25], 0, 0
    v_pk_mov_b32 v[26:27], 0, 0
    v_pk_mov_b32 v[28:29], 0, 0
    v_pk_mov_b32 v[30:31], 0, 0
    v_pk_mov_b32 v[32:33], 0, 0
    v_pk_mov_b32 v[34:35], 0, 0
    v_pk_mov_b32 v[36:37], 0, 0
    v_pk_mov_b32 v[38:39], 0, 0
    v_pk_mov_b32 v[40:41], 0, 0
    v_pk_mov_b32 v[42:43], 0, 0
    v_pk_mov_b32 v[44:45], 0, 0
    v_pk_mov_b32 v[46:47], 0, 0
    v_pk_mov_b32 v[48:49], 0, 0
    v_pk_mov_b32 v[50:51], 0, 0
    v_pk_mov_b32 v[52:53], 0, 0
    v_pk_mov_b32 v[54:55], 0, 0
    v_pk_mov_b32 v[56:57], 0, 0
    v_pk_mov_b32 v[58:59], 0, 0
    v_pk_mov_b32 v[60:61], 0, 0
    v_pk_mov_b32 v[62:63], 0, 0
    v_pk_mov_b32 v[64:65], 0, 0
    v_pk_mov_b32 v[66:67], 0, 0
    v_pk_mov_b32 v[68:69], 0, 0
    v_pk_mov_b32 v[70:71], 0, 0
    v_pk_mov_b32 v[72:73], 0, 0
    v_pk_mov_b32 v[74:75], 0, 0
    v_pk_mov_b32 v[76:77], 0, 0
    v_pk_mov_b32 v[78:79], 0, 0
    v_pk_mov_b32 v[80:81], 0, 0
    v_pk_mov_b32 v[82:83], 0, 0
    v_pk_mov_b32 v[84:85], 0, 0
    v_pk_mov_b32 v[86:87], 0, 0
    v_pk_mov_b32 v[88:89], 0, 0
    v_pk_mov_b32 v[90:91], 0, 0
    v_pk_mov_b32 v[92:93], 0, 0
    v_pk_mov_b32 v[94:95], 0, 0
    v_pk_mov_b32 v[96:97], 0, 0
    v_pk_mov_b32 v[98:99], 0, 0
    v_pk_mov_b32 v[100:101], 0, 0
    v_pk_mov_b32 v[102:103], 0, 0
    v_pk_mov_b32 v[104:105], 0, 0
    v_pk_mov_b32 v[106:107], 0, 0
    v_pk_mov_b32 v[108:109], 0, 0
    v_pk_mov_b32 v[110:111], 0, 0
    v_pk_mov_b32 v[112:113], 0, 0
    v_pk_mov_b32 v[114:115], 0, 0
    v_pk_mov_b32 v[116:117], 0, 0
    v_pk_mov_b32 v[118:119], 0, 0
    v_pk_mov_b32 v[120:121], 0, 0
    v_pk_mov_b32 v[122:123], 0, 0
    v_pk_mov_b32 v[124:125], 0, 0
    v_pk_mov_b32 v[126:127], 0, 0
    v_pk_mov_b32 v[128:129], 0, 0
    v_pk_mov_b32 v[130:131], 0, 0
    s_mov_b32 s40, 0x10648279
    s_mov_b32 s41, s40
    s_mov_b32 s42, 0x53513513
    s_mov_b32 s43, 0x23759353
    s_mov_b32 s31, 147456
    s_mov_b32 s46, 49152
    s_mov_b32 s32, 0xbdd2d3e8
    s_mov_b32 s33, 0xbdd2d3e8
    v_mov_b32 v18, 0xc0135761
    v_mov_b32 v19, 0xc0135761
    v_and_b32 v7, 1, v2
    v_cmp_eq_u32 s[38:39], 1, v7
    v_lshrrev_b32 v4, 2, v2
    v_lshl_add_u32 v4, v4, 1, v7
    v_lshl_add_u32 v4, v3, 3, v4
    v_lshlrev_b32 v4, 4, v4
    s_lshl_b32 s24, s21, 2
    s_add_u32 s24, s24, s29
    s_lshl_b32 s34, s24, 12
    s_add_u32 s34, s34, 0
    s_lshl_b32 s35, s22, 9
    s_add_u32 s35, s35, s34
    s_mov_b32 s36, 0x33333333
    s_mov_b32 s37, 0x33333333
    s_lshl_b32 s48, s22, 6
    s_add_u32 s48, s48, s24
    s_mul_i32 s52, s48, 7168
    s_add_u32 s52, s52, 524288
    s_add_u32 s53, s52, 4096
    s_lshl_b32 s48, s48, 3
    v_and_b32 v242, 7, v2
    v_lshl_add_u32 v242, v3, 3, v242
    v_lshlrev_b32 v242, 4, v242
    v_lshrrev_b32 v7, 3, v2
    v_lshl_add_u32 v242, v7, 9, v242
    v_lshlrev_b32 v243, 4, v1
    s_mov_b32 s49, 1
    v_add_u32 v12, s31, v5
    v_add_u32 v13, s31, v6
    v_add_u32 v14, s46, v8
    v_add_u32 v15, s46, v9
    v_add_u32 v16, s46, v10
    v_add_u32 v17, s46, v11
    s_barrier
    ds_read_b128 v[132:135], v12 offset:0
    ds_read_b128 v[136:139], v12 offset:2048
    ds_read_b64_tr_b16 v[140:141], v14 offset:0
    ds_read_b64_tr_b16 v[142:143], v14 offset:512
    ds_read_b64_tr_b16 v[144:145], v15 offset:0
    ds_read_b64_tr_b16 v[146:147], v15 offset:512
    ds_read_b64_tr_b16 v[148:149], v16 offset:0
    ds_read_b64_tr_b16 v[150:151], v16 offset:512
    ds_read_b64_tr_b16 v[152:153], v17 offset:0
    ds_read_b64_tr_b16 v[154:155], v17 offset:512
    ds_read_b64_tr_b16 v[156:157], v14 offset:8192
    ds_read_b64_tr_b16 v[158:159], v14 offset:8704
    ds_read_b64_tr_b16 v[160:161], v15 offset:8192
    ds_read_b64_tr_b16 v[162:163], v15 offset:8704
    ds_read_b64_tr_b16 v[164:165], v16 offset:8192
    ds_read_b64_tr_b16 v[166:167], v16 offset:8704
    v_mov_b32 v246, 0
    global_load_dwordx2 v[248:249], v246, s[84:85] sc0 sc1
    s_mov_b32 s30, 0
.p2align 3
f_z2loop:
    s_waitcnt lgkmcnt(6)
    v_mfma_f32_16x16x32_bf16 v[20:23], v[132:135], v[140:143], v[20:23]
    ds_read_b64_tr_b16 v[156:157], v14 offset:8192
    ds_read_b64_tr_b16 v[158:159], v14 offset:8704
    v_mfma_f32_16x16x32_bf16 v[48:51], v[136:139], v[140:143], v[48:51]
    ds_read_b64_tr_b16 v[160:161], v15 offset:8192
    s_waitcnt lgkmcnt(7)
    v_mfma_f32_16x16x32_bf16 v[24:27], v[132:135], v[144:147], v[24:27]
    ds_read_b64_tr_b16 v[162:163], v15 offset:8704
    v_mfma_f32_16x16x32_bf16 v[52:55], v[136:139], v[144:147], v[52:55]
    ds_read_b64_tr_b16 v[164:165], v16 offset:8192
    ds_read_b64_tr_b16 v[166:167], v16 offset:8704
    s_waitcnt lgkmcnt(8)
    v_mfma_f32_16x16x32_bf16 v[28:31], v[132:135], v[148:151], v[28:31]
    ds_read_b128 v[168:171], v13 offset:0
    v_mfma_f32_16x16x32_bf16 v[56:59], v[136:139], v[148:151], v[56:59]
    ds_read_b128 v[172:175], v13 offset:2048
    ds_read_b64_tr_b16 v[176:177], v14 offset:4096
    s_waitcnt lgkmcnt(9)
    v_mfma_f32_16x16x32_bf16 v[32:35], v[132:135], v[152:155], v[32:35]
    ds_read_b64_tr_b16 v[178:179], v14 offset:4608
    v_mfma_f32_16x16x32_bf16 v[60:63], v[136:139], v[152:155], v[60:63]
    ds_read_b64_tr_b16 v[180:181], v15 offset:4096
    s_waitcnt lgkmcnt(8)
    v_mfma_f32_16x16x32_bf16 v[36:39], v[132:135], v[156:159], v[36:39]
    ds_read_b64_tr_b16 v[182:183], v15 offset:4608
    ds_read_b64_tr_b16 v[184:185], v16 offset:4096
    v_mfma_f32_16x16x32_bf16 v[64:67], v[136:139], v[156:159], v[64:67]
    ds_read_b64_tr_b16 v[186:187], v16 offset:4608
    s_waitcnt lgkmcnt(8)
    v_mfma_f32_16x16x32_bf16 v[40:43], v[132:135], v[160:163], v[40:43]
    ds_read_b64_tr_b16 v[188:189], v17 offset:4096
    ds_read_b64_tr_b16 v[190:191], v17 offset:4608
    v_mfma_f32_16x16x32_bf16 v[68:71], v[136:139], v[160:163], v[68:71]
    ds_read_b64_tr_b16 v[192:193], v14 offset:12288
    v_mfma_f32_16x16x32_bf16 v[44:47], v[132:135], v[164:167], v[44:47]
    ds_read_b64_tr_b16 v[194:195], v14 offset:12800
    v_mfma_f32_16x16x32_bf16 v[72:75], v[136:139], v[164:167], v[72:75]
    ds_read_b64_tr_b16 v[196:197], v15 offset:12288
    ds_read_b64_tr_b16 v[198:199], v15 offset:12800
    s_waitcnt lgkmcnt(9)
    v_mfma_f32_16x16x32_bf16 v[20:23], v[168:171], v[176:179], v[20:23]
    ds_read_b64_tr_b16 v[200:201], v16 offset:12288
    v_mfma_f32_16x16x32_bf16 v[48:51], v[172:175], v[176:179], v[48:51]
    ds_read_b64_tr_b16 v[202:203], v16 offset:12800
    s_waitcnt lgkmcnt(8)
    v_mfma_f32_16x16x32_bf16 v[24:27], v[168:171], v[180:183], v[24:27]
    s_lshr_b64 s[40:41], s[40:41], 4
    s_lshr_b64 s[42:43], s[42:43], 4
    s_and_b32 s31, s40, 15
    v_mfma_f32_16x16x32_bf16 v[52:55], v[172:175], v[180:183], v[52:55]
    s_lshl_b32 s31, s31, 14
    s_and_b32 s46, s42, 15
    s_lshl_b32 s46, s46, 14
    v_mfma_f32_16x16x32_bf16 v[28:31], v[168:171], v[184:187], v[28:31]
    v_add_u32 v12, s31, v5
    v_add_u32 v13, s31, v6
    v_add_u32 v14, s46, v8
    v_mfma_f32_16x16x32_bf16 v[56:59], v[172:175], v[184:187], v[56:59]
    v_add_u32 v15, s46, v9
    v_add_u32 v16, s46, v10
    v_add_u32 v17, s46, v11
    s_waitcnt lgkmcnt(2)
    v_mfma_f32_16x16x32_bf16 v[32:35], v[168:171], v[188:191], v[32:35]
    s_add_u32 s30, s30, 1
    s_cmp_eq_u32 s30, 8
    s_waitcnt lgkmcnt(0)
    s_barrier
    v_mfma_f32_16x16x32_bf16 v[60:63], v[172:175], v[188:191], v[60:63]
    ds_read_b128 v[132:135], v12 offset:0
    ds_read_b128 v[136:139], v12 offset:2048
    v_mfma_f32_16x16x32_bf16 v[36:39], v[168:171], v[192:195], v[36:39]
    ds_read_b64_tr_b16 v[140:141], v14 offset:0
    v_mfma_f32_16x16x32_bf16 v[64:67], v[172:175], v[192:195], v[64:67]
    ds_read_b64_tr_b16 v[142:143], v14 offset:512
    ds_read_b64_tr_b16 v[144:145], v15 offset:0
    v_mfma_f32_16x16x32_bf16 v[40:43], v[168:171], v[196:199], v[40:43]
    ds_read_b64_tr_b16 v[146:147], v15 offset:512
    v_mfma_f32_16x16x32_bf16 v[68:71], v[172:175], v[196:199], v[68:71]
    ds_read_b64_tr_b16 v[148:149], v16 offset:0
    v_mfma_f32_16x16x32_bf16 v[44:47], v[168:171], v[200:203], v[44:47]
    ds_read_b64_tr_b16 v[150:151], v16 offset:512
    ds_read_b64_tr_b16 v[152:153], v17 offset:0
    v_mfma_f32_16x16x32_bf16 v[72:75], v[172:175], v[200:203], v[72:75]
    ds_read_b64_tr_b16 v[154:155], v17 offset:512
    s_cbranch_scc0 f_z2loop
    s_waitcnt lgkmcnt(0)
    s_mov_b32 s47, 0
tag_70w:
    s_waitcnt vmcnt(0)
    v_readfirstlane_b32 s62, v248
    v_readfirstlane_b32 s63, v249
    s_add_u32 s47, s47, 1
    s_cmp_lg_u32 s62, 0
    s_cbranch_scc1 tag_70k
    global_load_dwordx2 v[248:249], v246, s[84:85] sc0 sc1
    s_cmp_lt_u32 s47, 0x40000
    s_cbranch_scc1 tag_70w
tag_70k:
    v_mov_b32 v228, s62
    v_mov_b32 v229, s63
    v_pk_mul_f32 v[168:169], v[20:21], v[20:21]
    v_pk_mul_f32 v[170:171], v[22:23], v[22:23]
    v_pk_mul_f32 v[172:173], v[48:49], v[48:49]
    v_pk_mul_f32 v[174:175], v[50:51], v[50:51]
    v_pk_fma_f32 v[168:169], v[168:169], s[32:33], v[18:19]
    v_pk_fma_f32 v[170:171], v[170:171], s[32:33], v[18:19]
    v_pk_fma_f32 v[172:173], v[172:173], s[32:33], v[18:19]
    v_pk_fma_f32 v[174:175], v[174:175], s[32:33], v[18:19]
    v_pk_mul_f32 v[168:169], v[168:169], v[20:21]
    v_pk_mul_f32 v[170:171], v[170:171], v[22:23]
    v_pk_mul_f32 v[172:173], v[172:173], v[48:49]
    v_pk_mul_f32 v[174:175], v[174:175], v[50:51]
    v_exp_f32 v168, v168
    v_exp_f32 v169, v169
    v_exp_f32 v170, v170
    v_exp_f32 v171, v171
    v_exp_f32 v172, v172
    v_exp_f32 v173, v173
    v_exp_f32 v174, v174
    v_exp_f32 v175, v175
    v_pk_add_f32 v[168:169], v[168:169], 1.0 op_sel_hi:[1,0]
    v_pk_add_f32 v[170:171], v[170:171], 1.0 op_sel_hi:[1,0]
    v_pk_add_f32 v[172:173], v[172:173], 1.0 op_sel_hi:[1,0]
    v_pk_add_f32 v[174:175], v[174:175], 1.0 op_sel_hi:[1,0]
    v_rcp_f32 v168, v168
    v_rcp_f32 v169, v169
    v_rcp_f32 v170, v170
    v_rcp_f32 v171, v171
    v_rcp_f32 v172, v172
    v_rcp_f32 v173, v173
    v_rcp_f32 v174, v174
    v_rcp_f32 v175, v175
    v_pk_mul_f32 v[20:21], v[20:21], v[168:169]
    v_pk_mul_f32 v[22:23], v[22:23], v[170:171]
    v_pk_mul_f32 v[48:49], v[48:49], v[172:173]
    v_pk_mul_f32 v[50:51], v[50:51], v[174:175]
    v_pk_mul_f32 v[212:213], v[20:21], v[20:21]
    v_pk_mul_f32 v[214:215], v[22:23], v[22:23]
    v_pk_mul_f32 v[216:217], v[48:49], v[48:49]
    v_pk_mul_f32 v[218:219], v[50:51], v[50:51]
    v_pk_mul_f32 v[168:169], v[24:25], v[24:25]
    v_pk_mul_f32 v[170:171], v[26:27], v[26:27]
    v_pk_mul_f32 v[172:173], v[52:53], v[52:53]
    v_pk_mul_f32 v[174:175], v[54:55], v[54:55]
    v_pk_fma_f32 v[168:169], v[168:169], s[32:33], v[18:19]
    v_pk_fma_f32 v[170:171], v[170:171], s[32:33], v[18:19]
    v_pk_fma_f32 v[172:173], v[172:173], s[32:33], v[18:19]
    v_pk_fma_f32 v[174:175], v[174:175], s[32:33], v[18:19]
    v_pk_mul_f32 v[168:169], v[168:169], v[24:25]
    v_pk_mul_f32 v[170:171], v[170:171], v[26:27]
    v_pk_mul_f32 v[172:173], v[172:173], v[52:53]
    v_pk_mul_f32 v[174:175], v[174:175], v[54:55]
    v_exp_f32 v168, v168
    v_exp_f32 v169, v169
    v_exp_f32 v170, v170
    v_exp_f32 v171, v171
    v_exp_f32 v172, v172
    v_exp_f32 v173, v173
    v_exp_f32 v174, v174
    v_exp_f32 v175, v175
    v_pk_add_f32 v[168:169], v[168:169], 1.0 op_sel_hi:[1,0]
    v_pk_add_f32 v[170:171], v[170:171], 1.0 op_sel_hi:[1,0]
    v_pk_add_f32 v[172:173], v[172:173], 1.0 op_sel_hi:[1,0]
    v_pk_add_f32 v[174:175], v[174:175], 1.0 op_sel_hi:[1,0]
    v_rcp_f32 v168, v168
    v_rcp_f32 v169, v169
    v_rcp_f32 v170, v170
    v_rcp_f32 v171, v171
    v_rcp_f32 v172, v172
    v_rcp_f32 v173, v173
    v_rcp_f32 v174, v174
    v_rcp_f32 v175, v175
    v_pk_mul_f32 v[24:25], v[24:25], v[168:169]
    v_pk_mul_f32 v[26:27], v[26:27], v[170:171]
    v_pk_mul_f32 v[52:53], v[52:53], v[172:173]
    v_pk_mul_f32 v[54:55], v[54:55], v[174:175]
    v_pk_fma_f32 v[212:213], v[24:25], v[24:25], v[212:213]
    v_pk_add_f32 v[204:205], v[24:25], v[20:21]
    v_pk_fma_f32 v[214:215], v[26:27], v[26:27], v[214:215]
    v_pk_add_f32 v[206:207], v[26:27], v[22:23]
    v_pk_fma_f32 v[216:217], v[52:53], v[52:53], v[216:217]
    v_pk_add_f32 v[208:209], v[52:53], v[48:49]
    v_pk_fma_f32 v[218:219], v[54:55], v[54:55], v[218:219]
    v_pk_add_f32 v[210:211], v[54:55], v[50:51]
    v_pk_mul_f32 v[168:169], v[28:29], v[28:29]
    v_pk_mul_f32 v[170:171], v[30:31], v[30:31]
    v_pk_mul_f32 v[172:173], v[56:57], v[56:57]
    v_pk_mul_f32 v[174:175], v[58:59], v[58:59]
    v_pk_fma_f32 v[168:169], v[168:169], s[32:33], v[18:19]
    v_pk_fma_f32 v[170:171], v[170:171], s[32:33], v[18:19]
    v_pk_fma_f32 v[172:173], v[172:173], s[32:33], v[18:19]
    v_pk_fma_f32 v[174:175], v[174:175], s[32:33], v[18:19]
    v_pk_mul_f32 v[168:169], v[168:169], v[28:29]
    v_pk_mul_f32 v[170:171], v[170:171], v[30:31]
    v_pk_mul_f32 v[172:173], v[172:173], v[56:57]
    v_pk_mul_f32 v[174:175], v[174:175], v[58:59]
    v_exp_f32 v168, v168
    v_exp_f32 v169, v169
    v_exp_f32 v170, v170
    v_exp_f32 v171, v171
    v_exp_f32 v172, v172
    v_exp_f32 v173, v173
    v_exp_f32 v174, v174
    v_exp_f32 v175, v175
    v_pk_add_f32 v[168:169], v[168:169], 1.0 op_sel_hi:[1,0]
    v_pk_add_f32 v[170:171], v[170:171], 1.0 op_sel_hi:[1,0]
    v_pk_add_f32 v[172:173], v[172:173], 1.0 op_sel_hi:[1,0]
    v_pk_add_f32 v[174:175], v[174:175], 1.0 op_sel_hi:[1,0]
    v_rcp_f32 v168, v168
    v_rcp_f32 v169, v169
    v_rcp_f32 v170, v170
    v_rcp_f32 v171, v171
    v_rcp_f32 v172, v172
    v_rcp_f32 v173, v173
    v_rcp_f32 v174, v174
    v_rcp_f32 v175, v175
    v_pk_mul_f32 v[28:29], v[28:29], v[168:169]
    v_pk_mul_f32 v[30:31], v[30:31], v[170:171]
    v_pk_mul_f32 v[56:57], v[56:57], v[172:173]
    v_pk_mul_f32 v[58:59], v[58:59], v[174:175]
    v_pk_fma_f32 v[212:213], v[28:29], v[28:29], v[212:213]
    v_pk_add_f32 v[204:205], v[28:29], v[204:205]
    v_pk_fma_f32 v[214:215], v[30:31], v[30:31], v[214:215]
    v_pk_add_f32 v[206:207], v[30:31], v[206:207]
    v_pk_fma_f32 v[216:217], v[56:57], v[56:57], v[216:217]
    v_pk_add_f32 v[208:209], v[56:57], v[208:209]
    v_pk_fma_f32 v[218:219], v[58:59], v[58:59], v[218:219]
    v_pk_add_f32 v[210:211], v[58:59], v[210:211]
    v_pk_mul_f32 v[168:169], v[32:33], v[32:33]
    v_pk_mul_f32 v[170:171], v[34:35], v[34:35]
    v_pk_mul_f32 v[172:173], v[60:61], v[60:61]
    v_pk_mul_f32 v[174:175], v[62:63], v[62:63]
    v_pk_fma_f32 v[168:169], v[168:169], s[32:33], v[18:19]
    v_pk_fma_f32 v[170:171], v[170:171], s[32:33], v[18:19]
    v_pk_fma_f32 v[172:173], v[172:173], s[32:33], v[18:19]
    v_pk_fma_f32 v[174:175], v[174:175], s[32:33], v[18:19]
    v_pk_mul_f32 v[168:169], v[168:169], v[32:33]
    v_pk_mul_f32 v[170:171], v[170:171], v[34:35]
    v_pk_mul_f32 v[172:173], v[172:173], v[60:61]
    v_pk_mul_f32 v[174:175], v[174:175], v[62:63]
    v_exp_f32 v168, v168
    v_exp_f32 v169, v169
    v_exp_f32 v170, v170
    v_exp_f32 v171, v171
    v_exp_f32 v172, v172
    v_exp_f32 v173, v173
    v_exp_f32 v174, v174
    v_exp_f32 v175, v175
    v_pk_add_f32 v[168:169], v[168:169], 1.0 op_sel_hi:[1,0]
    v_pk_add_f32 v[170:171], v[170:171], 1.0 op_sel_hi:[1,0]
    v_pk_add_f32 v[172:173], v[172:173], 1.0 op_sel_hi:[1,0]
    v_pk_add_f32 v[174:175], v[174:175], 1.0 op_sel_hi:[1,0]
    v_rcp_f32 v168, v168
    v_rcp_f32 v169, v169
    v_rcp_f32 v170, v170
    v_rcp_f32 v171, v171
    v_rcp_f32 v172, v172
    v_rcp_f32 v173, v173
    v_rcp_f32 v174, v174
    v_rcp_f32 v175, v175
    v_pk_mul_f32 v[32:33], v[32:33], v[168:169]
    v_pk_mul_f32 v[34:35], v[34:35], v[170:171]
    v_pk_mul_f32 v[60:61], v[60:61], v[172:173]
    v_pk_mul_f32 v[62:63], v[62:63], v[174:175]
    v_pk_fma_f32 v[212:213], v[32:33], v[32:33], v[212:213]
    v_pk_add_f32 v[204:205], v[32:33], v[204:205]
    v_pk_fma_f32 v[214:215], v[34:35], v[34:35], v[214:215]
    v_pk_add_f32 v[206:207], v[34:35], v[206:207]
    v_pk_fma_f32 v[216:217], v[60:61], v[60:61], v[216:217]
    v_pk_add_f32 v[208:209], v[60:61], v[208:209]
    v_pk_fma_f32 v[218:219], v[62:63], v[62:63], v[218:219]
    v_pk_add_f32 v[210:211], v[62:63], v[210:211]
    v_pk_mul_f32 v[168:169], v[36:37], v[36:37]
    v_pk_mul_f32 v[170:171], v[38:39], v[38:39]
    v_pk_mul_f32 v[172:173], v[64:65], v[64:65]
    v_pk_mul_f32 v[174:175], v[66:67], v[66:67]
    v_pk_fma_f32 v[168:169], v[168:169], s[32:33], v[18:19]
    v_pk_fma_f32 v[170:171], v[170:171], s[32:33], v[18:19]
    v_pk_fma_f32 v[172:173], v[172:173], s[32:33], v[18:19]
    v_pk_fma_f32 v[174:175], v[174:175], s[32:33], v[18:19]
    v_pk_mul_f32 v[168:169], v[168:169], v[36:37]
    v_pk_mul_f32 v[170:171], v[170:171], v[38:39]
    v_pk_mul_f32 v[172:173], v[172:173], v[64:65]
    v_pk_mul_f32 v[174:175], v[174:175], v[66:67]
    v_exp_f32 v168, v168
    v_exp_f32 v169, v169
    v_exp_f32 v170, v170
    v_exp_f32 v171, v171
    v_exp_f32 v172, v172
    v_exp_f32 v173, v173
    v_exp_f32 v174, v174
    v_exp_f32 v175, v175
    v_pk_add_f32 v[168:169], v[168:169], 1.0 op_sel_hi:[1,0]
    v_pk_add_f32 v[170:171], v[170:171], 1.0 op_sel_hi:[1,0]
    v_pk_add_f32 v[172:173], v[172:173], 1.0 op_sel_hi:[1,0]
    v_pk_add_f32 v[174:175], v[174:175], 1.0 op_sel_hi:[1,0]
    v_rcp_f32 v168, v168
    v_rcp_f32 v169, v169
    v_rcp_f32 v170, v170
    v_rcp_f32 v171, v171
    v_rcp_f32 v172, v172
    v_rcp_f32 v173, v173
    v_rcp_f32 v174, v174
    v_rcp_f32 v175, v175
    v_pk_mul_f32 v[36:37], v[36:37], v[168:169]
    v_pk_mul_f32 v[38:39], v[38:39], v[170:171]
    v_pk_mul_f32 v[64:65], v[64:65], v[172:173]
    v_pk_mul_f32 v[66:67], v[66:67], v[174:175]
    v_pk_fma_f32 v[212:213], v[36:37], v[36:37], v[212:213]
    v_pk_add_f32 v[204:205], v[36:37], v[204:205]
    v_pk_fma_f32 v[214:215], v[38:39], v[38:39], v[214:215]
    v_pk_add_f32 v[206:207], v[38:39], v[206:207]
    v_pk_fma_f32 v[216:217], v[64:65], v[64:65], v[216:217]
    v_pk_add_f32 v[208:209], v[64:65], v[208:209]
    v_pk_fma_f32 v[218:219], v[66:67], v[66:67], v[218:219]
    v_pk_add_f32 v[210:211], v[66:67], v[210:211]
    v_pk_mul_f32 v[168:169], v[40:41], v[40:41]
    v_pk_mul_f32 v[170:171], v[42:43], v[42:43]
    v_pk_mul_f32 v[172:173], v[68:69], v[68:69]
    v_pk_mul_f32 v[174:175], v[70:71], v[70:71]
    v_pk_fma_f32 v[168:169], v[168:169], s[32:33], v[18:19]
    v_pk_fma_f32 v[170:171], v[170:171], s[32:33], v[18:19]
    v_pk_fma_f32 v[172:173], v[172:173], s[32:33], v[18:19]
    v_pk_fma_f32 v[174:175], v[174:175], s[32:33], v[18:19]
    v_pk_mul_f32 v[168:169], v[168:169], v[40:41]
    v_pk_mul_f32 v[170:171], v[170:171], v[42:43]
    v_pk_mul_f32 v[172:173], v[172:173], v[68:69]
    v_pk_mul_f32 v[174:175], v[174:175], v[70:71]
    v_exp_f32 v168, v168
    v_exp_f32 v169, v169
    v_exp_f32 v170, v170
    v_exp_f32 v171, v171
    v_exp_f32 v172, v172
    v_exp_f32 v173, v173
    v_exp_f32 v174, v174
    v_exp_f32 v175, v175
    v_pk_add_f32 v[168:169], v[168:169], 1.0 op_sel_hi:[1,0]
    v_pk_add_f32 v[170:171], v[170:171], 1.0 op_sel_hi:[1,0]
    v_pk_add_f32 v[172:173], v[172:173], 1.0 op_sel_hi:[1,0]
    v_pk_add_f32 v[174:175], v[174:175], 1.0 op_sel_hi:[1,0]
    v_rcp_f32 v168, v168
    v_rcp_f32 v169, v169
    v_rcp_f32 v170, v170
    v_rcp_f32 v171, v171
    v_rcp_f32 v172, v172
    v_rcp_f32 v173, v173
    v_rcp_f32 v174, v174
    v_rcp_f32 v175, v175
    v_pk_mul_f32 v[40:41], v[40:41], v[168:169]
    v_pk_mul_f32 v[42:43], v[42:43], v[170:171]
    v_pk_mul_f32 v[68:69], v[68:69], v[172:173]
    v_pk_mul_f32 v[70:71], v[70:71], v[174:175]
    v_pk_fma_f32 v[212:213], v[40:41], v[40:41], v[212:213]
    v_pk_add_f32 v[204:205], v[40:41], v[204:205]
    v_pk_fma_f32 v[214:215], v[42:43], v[42:43], v[214:215]
    v_pk_add_f32 v[206:207], v[42:43], v[206:207]
    v_pk_fma_f32 v[216:217], v[68:69], v[68:69], v[216:217]
    v_pk_add_f32 v[208:209], v[68:69], v[208:209]
    v_pk_fma_f32 v[218:219], v[70:71], v[70:71], v[218:219]
    v_pk_add_f32 v[210:211], v[70:71], v[210:211]
    v_pk_mul_f32 v[168:169], v[44:45], v[44:45]
    v_pk_mul_f32 v[170:171], v[46:47], v[46:47]
    v_pk_mul_f32 v[172:173], v[72:73], v[72:73]
    v_pk_mul_f32 v[174:175], v[74:75], v[74:75]
    v_pk_fma_f32 v[168:169], v[168:169], s[32:33], v[18:19]
    v_pk_fma_f32 v[170:171], v[170:171], s[32:33], v[18:19]
    v_pk_fma_f32 v[172:173], v[172:173], s[32:33], v[18:19]
    v_pk_fma_f32 v[174:175], v[174:175], s[32:33], v[18:19]
    v_pk_mul_f32 v[168:169], v[168:169], v[44:45]
    v_pk_mul_f32 v[170:171], v[170:171], v[46:47]
    v_pk_mul_f32 v[172:173], v[172:173], v[72:73]
    v_pk_mul_f32 v[174:175], v[174:175], v[74:75]
    v_exp_f32 v168, v168
    v_exp_f32 v169, v169
    v_exp_f32 v170, v170
    v_exp_f32 v171, v171
    v_exp_f32 v172, v172
    v_exp_f32 v173, v173
    v_exp_f32 v174, v174
    v_exp_f32 v175, v175
    v_pk_add_f32 v[168:169], v[168:169], 1.0 op_sel_hi:[1,0]
    v_pk_add_f32 v[170:171], v[170:171], 1.0 op_sel_hi:[1,0]
    v_pk_add_f32 v[172:173], v[172:173], 1.0 op_sel_hi:[1,0]
    v_pk_add_f32 v[174:175], v[174:175], 1.0 op_sel_hi:[1,0]
    v_rcp_f32 v168, v168
    v_rcp_f32 v169, v169
    v_rcp_f32 v170, v170
    v_rcp_f32 v171, v171
    v_rcp_f32 v172, v172
    v_rcp_f32 v173, v173
    v_rcp_f32 v174, v174
    v_rcp_f32 v175, v175
    v_pk_mul_f32 v[44:45], v[44:45], v[168:169]
    v_pk_mul_f32 v[46:47], v[46:47], v[170:171]
    v_pk_mul_f32 v[72:73], v[72:73], v[172:173]
    v_pk_mul_f32 v[74:75], v[74:75], v[174:175]
    v_pk_fma_f32 v[212:213], v[44:45], v[44:45], v[212:213]
    v_pk_add_f32 v[204:205], v[44:45], v[204:205]
    v_pk_fma_f32 v[214:215], v[46:47], v[46:47], v[214:215]
    v_pk_add_f32 v[206:207], v[46:47], v[206:207]
    v_pk_fma_f32 v[216:217], v[72:73], v[72:73], v[216:217]
    v_pk_add_f32 v[208:209], v[72:73], v[208:209]
    v_pk_fma_f32 v[218:219], v[74:75], v[74:75], v[218:219]
    v_pk_add_f32 v[210:211], v[74:75], v[210:211]
    v_add_f32_dpp v204, v204, v204 row_ror:8 row_mask:0xf bank_mask:0x3
    v_add_f32_dpp v205, v205, v205 row_ror:8 row_mask:0xf bank_mask:0x3
    v_add_f32_dpp v208, v208, v208 row_ror:8 row_mask:0xf bank_mask:0x3
    v_add_f32_dpp v209, v209, v209 row_ror:8 row_mask:0xf bank_mask:0x3
    v_add_f32_dpp v212, v212, v212 row_ror:8 row_mask:0xf bank_mask:0x3
    v_add_f32_dpp v213, v213, v213 row_ror:8 row_mask:0xf bank_mask:0x3
    v_add_f32_dpp v216, v216, v216 row_ror:8 row_mask:0xf bank_mask:0x3
    v_add_f32_dpp v217, v217, v217 row_ror:8 row_mask:0xf bank_mask:0x3
    v_add_f32_dpp v204, v206, v206 row_ror:8 row_mask:0xf bank_mask:0xc
    v_add_f32_dpp v205, v207, v207 row_ror:8 row_mask:0xf bank_mask:0xc
    v_add_f32_dpp v208, v210, v210 row_ror:8 row_mask:0xf bank_mask:0xc
    v_add_f32_dpp v209, v211, v211 row_ror:8 row_mask:0xf bank_mask:0xc
    v_add_f32_dpp v212, v214, v214 row_ror:8 row_mask:0xf bank_mask:0xc
    v_add_f32_dpp v213, v215, v215 row_ror:8 row_mask:0xf bank_mask:0xc
    v_add_f32_dpp v216, v218, v218 row_ror:8 row_mask:0xf bank_mask:0xc
    v_add_f32_dpp v217, v219, v219 row_ror:8 row_mask:0xf bank_mask:0xc
    v_add_f32_dpp v204, v204, v204 row_shl:4 row_mask:0xf bank_mask:0x5
    v_add_f32_dpp v208, v208, v208 row_shl:4 row_mask:0xf bank_mask:0x5
    v_add_f32_dpp v212, v212, v212 row_shl:4 row_mask:0xf bank_mask:0x5
    v_add_f32_dpp v216, v216, v216 row_shl:4 row_mask:0xf bank_mask:0x5
    v_add_f32_dpp v204, v205, v205 row_shr:4 row_mask:0xf bank_mask:0xa
    v_add_f32_dpp v208, v209, v209 row_shr:4 row_mask:0xf bank_mask:0xa
    v_add_f32_dpp v212, v213, v213 row_shr:4 row_mask:0xf bank_mask:0xa
    v_add_f32_dpp v216, v217, v217 row_shr:4 row_mask:0xf bank_mask:0xa
    v_add_f32_dpp v204, v204, v204 quad_perm:[1,0,3,2] row_mask:0xf bank_mask:0xf
    v_add_f32_dpp v208, v208, v208 quad_perm:[1,0,3,2] row_mask:0xf bank_mask:0xf
    v_add_f32_dpp v212, v212, v212 quad_perm:[1,0,3,2] row_mask:0xf bank_mask:0xf
    v_add_f32_dpp v216, v216, v216 quad_perm:[1,0,3,2] row_mask:0xf bank_mask:0xf
    v_add_f32_dpp v204, v204, v204 quad_perm:[2,3,0,1] row_mask:0xf bank_mask:0xf
    v_add_f32_dpp v208, v208, v208 quad_perm:[2,3,0,1] row_mask:0xf bank_mask:0xf
    v_add_f32_dpp v212, v212, v212 quad_perm:[2,3,0,1] row_mask:0xf bank_mask:0xf
    v_add_f32_dpp v216, v216, v216 quad_perm:[2,3,0,1] row_mask:0xf bank_mask:0xf
    v_cndmask_b32 v226, v204, v208, s[38:39]
    v_cndmask_b32 v227, v212, v216, s[38:39]
    s_mov_b64 exec, s[36:37]
    buffer_store_dwordx4 v[226:229], v4, s[12:15], s35 offen sc0 sc1
    s_mov_b64 exec, -1
    s_barrier
    ds_read_b128 v[132:135], v12 offset:0
    ds_read_b128 v[136:139], v12 offset:2048
    ds_read_b64_tr_b16 v[140:141], v14 offset:0
    ds_read_b64_tr_b16 v[142:143], v14 offset:512
    ds_read_b64_tr_b16 v[144:145], v15 offset:0
    ds_read_b64_tr_b16 v[146:147], v15 offset:512
    ds_read_b64_tr_b16 v[148:149], v16 offset:0
    ds_read_b64_tr_b16 v[150:151], v16 offset:512
    ds_read_b64_tr_b16 v[152:153], v17 offset:0
    ds_read_b64_tr_b16 v[154:155], v17 offset:512
    ds_read_b64_tr_b16 v[156:157], v14 offset:8192
    ds_read_b64_tr_b16 v[158:159], v14 offset:8704
    ds_read_b64_tr_b16 v[160:161], v15 offset:8192
    ds_read_b64_tr_b16 v[162:163], v15 offset:8704
    ds_read_b64_tr_b16 v[164:165], v16 offset:8192
    ds_read_b64_tr_b16 v[166:167], v16 offset:8704
    s_mov_b32 s30, 0
.p2align 3
f_z1loop:
    s_waitcnt lgkmcnt(6)
    v_mfma_f32_16x16x32_bf16 v[76:79], v[140:143], v[132:135], v[76:79]
    ds_read_b64_tr_b16 v[156:157], v14 offset:8192
    ds_read_b64_tr_b16 v[158:159], v14 offset:8704
    v_mfma_f32_16x16x32_bf16 v[104:107], v[140:143], v[136:139], v[104:107]
    ds_read_b64_tr_b16 v[160:161], v15 offset:8192
    s_waitcnt lgkmcnt(7)
    v_mfma_f32_16x16x32_bf16 v[80:83], v[144:147], v[132:135], v[80:83]
    ds_read_b64_tr_b16 v[162:163], v15 offset:8704
    v_mfma_f32_16x16x32_bf16 v[108:111], v[144:147], v[136:139], v[108:111]
    ds_read_b64_tr_b16 v[164:165], v16 offset:8192
    ds_read_b64_tr_b16 v[166:167], v16 offset:8704
    s_waitcnt lgkmcnt(8)
    v_mfma_f32_16x16x32_bf16 v[84:87], v[148:151], v[132:135], v[84:87]
    ds_read_b128 v[168:171], v13 offset:0
    v_mfma_f32_16x16x32_bf16 v[112:115], v[148:151], v[136:139], v[112:115]
    ds_read_b128 v[172:175], v13 offset:2048
    ds_read_b64_tr_b16 v[176:177], v14 offset:4096
    s_waitcnt lgkmcnt(9)
    v_mfma_f32_16x16x32_bf16 v[88:91], v[152:155], v[132:135], v[88:91]
    ds_read_b64_tr_b16 v[178:179], v14 offset:4608
    v_mfma_f32_16x16x32_bf16 v[116:119], v[152:155], v[136:139], v[116:119]
    ds_read_b64_tr_b16 v[180:181], v15 offset:4096
    s_waitcnt lgkmcnt(8)
    v_mfma_f32_16x16x32_bf16 v[92:95], v[156:159], v[132:135], v[92:95]
    ds_read_b64_tr_b16 v[182:183], v15 offset:4608
    ds_read_b64_tr_b16 v[184:185], v16 offset:4096
    v_mfma_f32_16x16x32_bf16 v[120:123], v[156:159], v[136:139], v[120:123]
    ds_read_b64_tr_b16 v[186:187], v16 offset:4608
    s_waitcnt lgkmcnt(8)
    v_mfma_f32_16x16x32_bf16 v[96:99], v[160:163], v[132:135], v[96:99]
    ds_read_b64_tr_b16 v[188:189], v17 offset:4096
    ds_read_b64_tr_b16 v[190:191], v17 offset:4608
    v_mfma_f32_16x16x32_bf16 v[124:127], v[160:163], v[136:139], v[124:127]
    ds_read_b64_tr_b16 v[192:193], v14 offset:12288
    v_mfma_f32_16x16x32_bf16 v[100:103], v[164:167], v[132:135], v[100:103]
    ds_read_b64_tr_b16 v[194:195], v14 offset:12800
    v_mfma_f32_16x16x32_bf16 v[128:131], v[164:167], v[136:139], v[128:131]
    ds_read_b64_tr_b16 v[196:197], v15 offset:12288
    ds_read_b64_tr_b16 v[198:199], v15 offset:12800
    s_waitcnt lgkmcnt(9)
    v_mfma_f32_16x16x32_bf16 v[76:79], v[176:179], v[168:171], v[76:79]
    ds_read_b64_tr_b16 v[200:201], v16 offset:12288
    v_mfma_f32_16x16x32_bf16 v[104:107], v[176:179], v[172:175], v[104:107]
    ds_read_b64_tr_b16 v[202:203], v16 offset:12800
    s_waitcnt lgkmcnt(8)
    v_mfma_f32_16x16x32_bf16 v[80:83], v[180:183], v[168:171], v[80:83]
    s_lshr_b64 s[40:41], s[40:41], 4
    s_lshr_b64 s[42:43], s[42:43], 4
    s_and_b32 s31, s40, 15
    s_lshl_b32 s31, s31, 14
    v_mfma_f32_16x16x32_bf16 v[108:111], v[180:183], v[172:175], v[108:111]
    s_and_b32 s46, s42, 15
    s_lshl_b32 s46, s46, 14
    s_cmp_eq_u32 s30, s49
    s_cbranch_scc1 f_mhook
f_mhookr:
    v_mfma_f32_16x16x32_bf16 v[84:87], v[184:187], v[168:171], v[84:87]
    v_add_u32 v12, s31, v5
    v_add_u32 v13, s31, v6
    v_add_u32 v14, s46, v8
    v_add_u32 v15, s46, v9
    v_mfma_f32_16x16x32_bf16 v[112:115], v[184:187], v[172:175], v[112:115]
    v_add_u32 v16, s46, v10
    v_add_u32 v17, s46, v11
    s_add_u32 s30, s30, 1
    s_cmp_eq_u32 s30, 8
    s_waitcnt lgkmcnt(2)
    v_mfma_f32_16x16x32_bf16 v[88:91], v[188:191], v[168:171], v[88:91]
    s_waitcnt lgkmcnt(0)
    s_cbranch_scc1 f_z1loop_nb
    s_barrier
f_z1loop_nb:
    v_mfma_f32_16x16x32_bf16 v[116:119], v[188:191], v[172:175], v[116:119]
    ds_read_b128 v[132:135], v12 offset:0
    ds_read_b128 v[136:139], v12 offset:2048
    v_mfma_f32_16x16x32_bf16 v[92:95], v[192:195], v[168:171], v[92:95]
    ds_read_b64_tr_b16 v[140:141], v14 offset:0
    v_mfma_f32_16x16x32_bf16 v[120:123], v[192:195], v[172:175], v[120:123]
    ds_read_b64_tr_b16 v[142:143], v14 offset:512
    ds_read_b64_tr_b16 v[144:145], v15 offset:0
    v_mfma_f32_16x16x32_bf16 v[96:99], v[196:199], v[168:171], v[96:99]
    ds_read_b64_tr_b16 v[146:147], v15 offset:512
    v_mfma_f32_16x16x32_bf16 v[124:127], v[196:199], v[172:175], v[124:127]
    ds_read_b64_tr_b16 v[148:149], v16 offset:0
    v_mfma_f32_16x16x32_bf16 v[100:103], v[200:203], v[168:171], v[100:103]
    ds_read_b64_tr_b16 v[150:151], v16 offset:512
    ds_read_b64_tr_b16 v[152:153], v17 offset:0
    v_mfma_f32_16x16x32_bf16 v[128:131], v[200:203], v[172:175], v[128:131]
    ds_read_b64_tr_b16 v[154:155], v17 offset:512
    s_cbranch_scc0 f_z1loop
    s_waitcnt lgkmcnt(0)
    s_barrier
    v_lshlrev_b32 v238, 16, v251
    v_and_b32 v240, 0xffff0000, v251
    s_mov_b32 s51, 18
    v_lshlrev_b32 v7, 2, v3
    v_sub_u32 v7, v2, v7
    v_mov_b32 v9, 0x3f80
    v_mov_b32 v10, 0x3f800000
    v_cmp_eq_u32 vcc, 0, v7
    v_cmp_eq_u32 s[36:37], 1, v7
    s_nop 0
    v_cndmask_b32 v246, 0, v9, vcc
    v_cndmask_b32 v246, v246, v10, s[36:37]
    v_cmp_eq_u32 vcc, 2, v7
    v_cmp_eq_u32 s[36:37], 3, v7
    s_nop 0
    v_cndmask_b32 v247, 0, v9, vcc
    v_cndmask_b32 v247, v247, v10, s[36:37]
    s_branch f_join
f_mhook:
    s_cmp_eq_u32 s49, 1
    s_cbranch_scc0 f_mhook2
    s_mov_b32 s49, 2
    buffer_load_dwordx4 v[226:229], v242, s[12:15], s34 offen offset:0 sc0 sc1
    buffer_load_dwordx4 v[230:233], v242, s[12:15], s34 offen offset:1024 sc0 sc1
    buffer_load_dwordx4 v[234:237], v242, s[12:15], s34 offen offset:2048 sc0 sc1
    buffer_load_dwordx4 v[238:241], v242, s[12:15], s34 offen offset:3072 sc0 sc1
    s_branch f_mhookr
f_mhook2:
    s_cmp_eq_u32 s49, 2
    s_cbranch_scc1 f_mhook3
    s_add_u32 s49, s48, 262144
    v_mov_b32 v244, s62
    v_mov_b32 v245, s63
    s_waitcnt vmcnt(0)
    s_mov_b64 exec, 1
    buffer_store_dwordx2 v[244:245], off, s[12:15], s49 sc0 sc1
    s_mov_b64 exec, -1
    s_branch f_mhookr
f_mhook3:
    s_mov_b32 s49, 3
    s_mov_b32 s47, 0
    s_branch f_pollc
f_poll:
    buffer_load_dwordx4 v[226:229], v242, s[12:15], s34 offen offset:0 sc0 sc1
    buffer_load_dwordx4 v[230:233], v242, s[12:15], s34 offen offset:1024 sc0 sc1
    buffer_load_dwordx4 v[234:237], v242, s[12:15], s34 offen offset:2048 sc0 sc1
    buffer_load_dwordx4 v[238:241], v242, s[12:15], s34 offen offset:3072 sc0 sc1
f_pollc:
    s_waitcnt vmcnt(0)
    v_xor_b32 v7, s62, v228
    v_xor_b32 v4, s63, v229
    v_or_b32 v7, v7, v4
    v_xor_b32 v4, s62, v232
    v_xor_b32 v232, s63, v233
    v_or3_b32 v7, v7, v4, v232
    v_xor_b32 v4, s62, v236
    v_xor_b32 v236, s63, v237
    v_or3_b32 v7, v7, v4, v236
    v_xor_b32 v4, s62, v240
    v_xor_b32 v240, s63, v241
    v_or3_b32 v7, v7, v4, v240
    v_cmp_ne_u32 vcc, 0, v7
    s_add_u32 s47, s47, 1
    s_cmp_gt_u32 s47, 0x40000
    s_cbranch_scc1 f_pollx
    s_cbranch_vccnz f_poll
f_pollx:
    v_pk_add_f32 v[226:227], v[226:227], v[230:231]
    v_pk_add_f32 v[234:235], v[234:235], v[238:239]
    v_pk_add_f32 v[226:227], v[226:227], v[234:235]
    s_nop 1
    v_add_f32_dpp v226, v226, v226 row_ror:8 row_mask:0xf bank_mask:0xf
    v_add_f32_dpp v227, v227, v227 row_ror:8 row_mask:0xf bank_mask:0xf
    v_mul_f32 v226, 0x3a924925, v226
    v_mul_f32 v227, 0x3a924925, v227
    v_fma_f32 v227, -v226, v226, v227
    v_max_f32 v227, 0, v227
    v_add_f32 v227, 0x3727c5ac, v227
    v_rsq_f32 v227, v227
    s_nop 0
    v_mul_f32 v226, v226, v227
    v_sub_f32 v226, 0, v226
    v_mov_b32_dpp v212, v227 row_newbcast:0 row_mask:0xf bank_mask:0xf
    s_nop 0
    v_mov_b32_dpp v204, v226 row_newbcast:0 row_mask:0xf bank_mask:0xf
    v_mov_b32_dpp v213, v227 row_newbcast:2 row_mask:0xf bank_mask:0xf
    v_mov_b32_dpp v205, v226 row_newbcast:2 row_mask:0xf bank_mask:0xf
    v_mov_b32_dpp v214, v227 row_newbcast:4 row_mask:0xf bank_mask:0xf
    v_mov_b32_dpp v206, v226 row_newbcast:4 row_mask:0xf bank_mask:0xf
    v_mov_b32_dpp v215, v227 row_newbcast:6 row_mask:0xf bank_mask:0xf
    v_mov_b32_dpp v207, v226 row_newbcast:6 row_mask:0xf bank_mask:0xf
    v_mov_b32_dpp v216, v227 row_newbcast:1 row_mask:0xf bank_mask:0xf
    v_mov_b32_dpp v208, v226 row_newbcast:1 row_mask:0xf bank_mask:0xf
    v_mov_b32_dpp v217, v227 row_newbcast:3 row_mask:0xf bank_mask:0xf
    v_mov_b32_dpp v209, v226 row_newbcast:3 row_mask:0xf bank_mask:0xf
    v_mov_b32_dpp v218, v227 row_newbcast:5 row_mask:0xf bank_mask:0xf
    v_mov_b32_dpp v210, v226 row_newbcast:5 row_mask:0xf bank_mask:0xf
    v_mov_b32_dpp v219, v227 row_newbcast:7 row_mask:0xf bank_mask:0xf
    v_mov_b32_dpp v211, v226 row_newbcast:7 row_mask:0xf bank_mask:0xf
    v_pk_fma_f32 v[20:21], v[20:21], v[212:213], v[204:205]
    v_pk_fma_f32 v[22:23], v[22:23], v[214:215], v[206:207]
    v_pk_fma_f32 v[48:49], v[48:49], v[216:217], v[208:209]
    v_pk_fma_f32 v[50:51], v[50:51], v[218:219], v[210:211]
    v_cvt_pk_bf16_f32 v20, v20, v48
    v_cvt_pk_bf16_f32 v21, v21, v49
    v_cvt_pk_bf16_f32 v22, v22, v50
    v_cvt_pk_bf16_f32 v23, v23, v51
    buffer_store_dwordx4 v[20:23], v243, s[12:15], s52 offen offset:0 sc0 sc1
    v_pk_fma_f32 v[24:25], v[24:25], v[212:213], v[204:205]
    v_pk_fma_f32 v[26:27], v[26:27], v[214:215], v[206:207]
    v_pk_fma_f32 v[52:53], v[52:53], v[216:217], v[208:209]
    v_pk_fma_f32 v[54:55], v[54:55], v[218:219], v[210:211]
    v_cvt_pk_bf16_f32 v24, v24, v52
    v_cvt_pk_bf16_f32 v25, v25, v53
    v_cvt_pk_bf16_f32 v26, v26, v54
    v_cvt_pk_bf16_f32 v27, v27, v55
    buffer_store_dwordx4 v[24:27], v243, s[12:15], s52 offen offset:1024 sc0 sc1
    v_pk_fma_f32 v[28:29], v[28:29], v[212:213], v[204:205]
    v_pk_fma_f32 v[30:31], v[30:31], v[214:215], v[206:207]
    v_pk_fma_f32 v[56:57], v[56:57], v[216:217], v[208:209]
    v_pk_fma_f32 v[58:59], v[58:59], v[218:219], v[210:211]
    v_cvt_pk_bf16_f32 v28, v28, v56
    v_cvt_pk_bf16_f32 v29, v29, v57
    v_cvt_pk_bf16_f32 v30, v30, v58
    v_cvt_pk_bf16_f32 v31, v31, v59
    buffer_store_dwordx4 v[28:31], v243, s[12:15], s52 offen offset:2048 sc0 sc1
    v_pk_fma_f32 v[32:33], v[32:33], v[212:213], v[204:205]
    v_pk_fma_f32 v[34:35], v[34:35], v[214:215], v[206:207]
    v_pk_fma_f32 v[60:61], v[60:61], v[216:217], v[208:209]
    v_pk_fma_f32 v[62:63], v[62:63], v[218:219], v[210:211]
    v_cvt_pk_bf16_f32 v32, v32, v60
    v_cvt_pk_bf16_f32 v33, v33, v61
    v_cvt_pk_bf16_f32 v34, v34, v62
    v_cvt_pk_bf16_f32 v35, v35, v63
    buffer_store_dwordx4 v[32:35], v243, s[12:15], s52 offen offset:3072 sc0 sc1
    v_pk_fma_f32 v[36:37], v[36:37], v[212:213], v[204:205]
    v_pk_fma_f32 v[38:39], v[38:39], v[214:215], v[206:207]
    v_pk_fma_f32 v[64:65], v[64:65], v[216:217], v[208:209]
    v_pk_fma_f32 v[66:67], v[66:67], v[218:219], v[210:211]
    v_cvt_pk_bf16_f32 v36, v36, v64
    v_cvt_pk_bf16_f32 v37, v37, v65
    v_cvt_pk_bf16_f32 v38, v38, v66
    v_cvt_pk_bf16_f32 v39, v39, v67
    buffer_store_dwordx4 v[36:39], v243, s[12:15], s53 offen offset:0 sc0 sc1
    v_pk_fma_f32 v[40:41], v[40:41], v[212:213], v[204:205]
    v_pk_fma_f32 v[42:43], v[42:43], v[214:215], v[206:207]
    v_pk_fma_f32 v[68:69], v[68:69], v[216:217], v[208:209]
    v_pk_fma_f32 v[70:71], v[70:71], v[218:219], v[210:211]
    v_cvt_pk_bf16_f32 v40, v40, v68
    v_cvt_pk_bf16_f32 v41, v41, v69
    v_cvt_pk_bf16_f32 v42, v42, v70
    v_cvt_pk_bf16_f32 v43, v43, v71
    buffer_store_dwordx4 v[40:43], v243, s[12:15], s53 offen offset:1024 sc0 sc1
    v_pk_fma_f32 v[44:45], v[44:45], v[212:213], v[204:205]
    v_pk_fma_f32 v[46:47], v[46:47], v[214:215], v[206:207]
    v_pk_fma_f32 v[72:73], v[72:73], v[216:217], v[208:209]
    v_pk_fma_f32 v[74:75], v[74:75], v[218:219], v[210:211]
    v_cvt_pk_bf16_f32 v44, v44, v72
    v_cvt_pk_bf16_f32 v45, v45, v73
    v_cvt_pk_bf16_f32 v46, v46, v74
    v_cvt_pk_bf16_f32 v47, v47, v75
    buffer_store_dwordx4 v[44:47], v243, s[12:15], s53 offen offset:2048 sc0 sc1
    s_branch f_mhookr
f_attn:
    s_lshl_b32 s24, s21, 7
    s_lshl_b32 s25, s22, 4
    s_add_u32 s24, s24, s25
    s_lshl_b32 s25, s29, 2
    s_add_u32 s24, s24, s25
    s_lshl_b32 s25, s24, 10
    v_lshlrev_b32 v4, 4, v1
    buffer_load_dwordx4 v[132:135], v4, s[4:7], s25 offen offset:0
    buffer_load_dwordx4 v[136:139], v4, s[4:7], s25 offen offset:1024
    buffer_load_dwordx4 v[140:143], v4, s[4:7], s25 offen offset:2048
    buffer_load_dwordx4 v[144:147], v4, s[4:7], s25 offen offset:3072
    global_load_dwordx4 v[148:151], v4, s[80:81]
    v_lshrrev_b32 v7, 1, v2
    v_xor_b32 v7, v7, v3
    v_lshlrev_b32 v7, 4, v7
    v_lshl_add_u32 v5, v2, 7, v7
    v_xor_b32 v6, 64, v5
    v_lshrrev_b32 v7, 2, v2
    v_lshl_add_u32 v18, v3, 3, v7
    v_lshlrev_b32 v18, 7, v18
    v_and_b32 v19, 3, v2
    v_lshl_add_u32 v18, v19, 3, v18
    v_add_u32 v18, 20480, v18
    v_lshrrev_b32 v7, 3, v2
    v_and_b32 v19, 1, v3
    v_lshl_or_b32 v7, v19, 1, v7
    v_xor_b32 v7, s29, v7
    v_lshl_add_u32 v8, v7, 5, v18
    v_pk_mov_b32 v[20:21], 0, 0
    v_pk_mov_b32 v[22:23], 0, 0
    v_pk_mov_b32 v[24:25], 0, 0
    v_pk_mov_b32 v[26:27], 0, 0
    v_pk_mov_b32 v[28:29], 0, 0
    v_pk_mov_b32 v[30:31], 0, 0
    v_pk_mov_b32 v[32:33], 0, 0
    v_pk_mov_b32 v[34:35], 0, 0
    v_pk_mov_b32 v[36:37], 0, 0
    v_pk_mov_b32 v[38:39], 0, 0
    v_pk_mov_b32 v[40:41], 0, 0
    v_pk_mov_b32 v[42:43], 0, 0
    v_pk_mov_b32 v[44:45], 0, 0
    v_pk_mov_b32 v[46:47], 0, 0
    v_pk_mov_b32 v[48:49], 0, 0
    v_pk_mov_b32 v[50:51], 0, 0
    v_pk_mov_b32 v[52:53], 0, 0
    v_pk_mov_b32 v[54:55], 0, 0
    v_pk_mov_b32 v[56:57], 0, 0
    v_pk_mov_b32 v[58:59], 0, 0
    v_pk_mov_b32 v[60:61], 0, 0
    v_pk_mov_b32 v[62:63], 0, 0
    v_pk_mov_b32 v[64:65], 0, 0
    v_pk_mov_b32 v[66:67], 0, 0
    v_pk_mov_b32 v[68:69], 0, 0
    v_pk_mov_b32 v[70:71], 0, 0
    v_pk_mov_b32 v[72:73], 0, 0
    v_pk_mov_b32 v[74:75], 0, 0
    v_pk_mov_b32 v[76:77], 0, 0
    v_pk_mov_b32 v[78:79], 0, 0
    v_pk_mov_b32 v[80:81], 0, 0
    v_pk_mov_b32 v[82:83], 0, 0
    v_pk_mov_b32 v[84:85], 0, 0
    v_pk_mov_b32 v[86:87], 0, 0
    v_pk_mov_b32 v[88:89], 0, 0
    v_pk_mov_b32 v[90:91], 0, 0
    v_pk_mov_b32 v[92:93], 0, 0
    v_pk_mov_b32 v[94:95], 0, 0
    v_pk_mov_b32 v[96:97], 0, 0
    v_pk_mov_b32 v[98:99], 0, 0
    v_pk_mov_b32 v[100:101], 0, 0
    v_pk_mov_b32 v[102:103], 0, 0
    v_pk_mov_b32 v[104:105], 0, 0
    v_pk_mov_b32 v[106:107], 0, 0
    v_pk_mov_b32 v[108:109], 0, 0
    v_pk_mov_b32 v[110:111], 0, 0
    v_pk_mov_b32 v[112:113], 0, 0
    v_pk_mov_b32 v[114:115], 0, 0
    v_pk_mov_b32 v[116:117], 0, 0
    v_pk_mov_b32 v[118:119], 0, 0
    v_pk_mov_b32 v[120:121], 0, 0
    v_pk_mov_b32 v[122:123], 0, 0
    v_pk_mov_b32 v[124:125], 0, 0
    v_pk_mov_b32 v[126:127], 0, 0
    v_pk_mov_b32 v[128:129], 0, 0
    v_pk_mov_b32 v[130:131], 0, 0
    v_lshlrev_b32 v7, 2, v3
    v_sub_u32 v7, v2, v7
    v_mov_b32 v18, 0xf149f2ca
    v_subrev_u32 v19, 0, v7
    v_cmp_gt_u32 vcc, 8, v19
    v_cmp_gt_i32 s[38:39], -8, v19
    s_nop 0
    v_cndmask_b32 v236, v18, 0, vcc
    v_cndmask_b32 v240, v18, 0, s[38:39]
    v_cndmask_b32 v19, 0, -1, vcc
    v_and_b32 v244, 0xffff, v19
    v_subrev_u32 v19, 1, v7
    v_cmp_gt_u32 vcc, 8, v19
    v_cmp_gt_i32 s[38:39], -8, v19
    s_nop 0
    v_cndmask_b32 v237, v18, 0, vcc
    v_cndmask_b32 v241, v18, 0, s[38:39]
    v_cndmask_b32 v19, 0, -1, vcc
    v_and_b32 v19, 0xffff0000, v19
    v_or_b32 v244, v244, v19
    v_subrev_u32 v19, 2, v7
    v_cmp_gt_u32 vcc, 8, v19
    v_cmp_gt_i32 s[38:39], -8, v19
    s_nop 0
    v_cndmask_b32 v238, v18, 0, vcc
    v_cndmask_b32 v242, v18, 0, s[38:39]
    v_cndmask_b32 v19, 0, -1, vcc
    v_and_b32 v245, 0xffff, v19
    v_subrev_u32 v19, 3, v7
    v_cmp_gt_u32 vcc, 8, v19
    v_cmp_gt_i32 s[38:39], -8, v19
    s_nop 0
    v_cndmask_b32 v239, v18, 0, vcc
    v_cndmask_b32 v243, v18, 0, s[38:39]
    v_cndmask_b32 v19, 0, -1, vcc
    v_and_b32 v19, 0xffff0000, v19
    v_or_b32 v245, v245, v19
    v_not_b32 v246, v244
    v_not_b32 v247, v245
    s_cmp_eq_u32 s21, 0
    s_cselect_b32 s36, 0, -1
    s_mov_b32 s37, 0
    v_cmp_gt_i32 vcc, 0, v7
    s_nop 0
    s_and_b64 vcc, vcc, s[36:37]
    v_cndmask_b32 v72, v18, 0, vcc
    v_cmp_gt_i32 vcc, 1, v7
    s_nop 0
    s_and_b64 vcc, vcc, s[36:37]
    v_cndmask_b32 v73, v18, 0, vcc
    v_cmp_gt_i32 vcc, 2, v7
    s_nop 0
    s_and_b64 vcc, vcc, s[36:37]
    v_cndmask_b32 v74, v18, 0, vcc
    v_cmp_gt_i32 vcc, 3, v7
    s_nop 0
    s_and_b64 vcc, vcc, s[36:37]
    v_cndmask_b32 v75, v18, 0, vcc
    v_and_b32 v9, 7, v2
    v_lshrrev_b32 v10, 3, v2
    v_lshl_add_u32 v10, v10, 4, v9
    v_add_u32 v10, 8, v10
    v_lshrrev_b32 v9, 1, v9
    v_or_b32 v9, 4, v9
    v_xor_b32 v9, v9, v3
    v_lshlrev_b32 v9, 4, v9
    v_lshl_add_u32 v9, v10, 7, v9
    v_xor_b32 v10, 64, v9
    v_mov_b32 v152, 0
    v_mov_b32 v153, 0
    v_mov_b32 v154, 0
    v_mov_b32 v155, 0
    s_waitcnt vmcnt(0)
    v_dot2c_f32_bf16 v152, v132, v148
    v_dot2c_f32_bf16 v153, v136, v148
    v_dot2c_f32_bf16 v154, v140, v148
    v_dot2c_f32_bf16 v155, v144, v148
    v_dot2c_f32_bf16 v152, v133, v149
    v_dot2c_f32_bf16 v153, v137, v149
    v_dot2c_f32_bf16 v154, v141, v149
    v_dot2c_f32_bf16 v155, v145, v149
    v_dot2c_f32_bf16 v152, v134, v150
    v_dot2c_f32_bf16 v153, v138, v150
    v_dot2c_f32_bf16 v154, v142, v150
    v_dot2c_f32_bf16 v155, v146, v150
    v_dot2c_f32_bf16 v152, v135, v151
    v_dot2c_f32_bf16 v153, v139, v151
    v_dot2c_f32_bf16 v154, v143, v151
    v_dot2c_f32_bf16 v155, v147, v151
    v_add_f32_dpp v152, v152, v152 row_ror:8 row_mask:0xf bank_mask:0xf
    v_add_f32_dpp v153, v153, v153 row_ror:8 row_mask:0xf bank_mask:0xf
    v_add_f32_dpp v154, v154, v154 row_ror:8 row_mask:0xf bank_mask:0xf
    v_add_f32_dpp v155, v155, v155 row_ror:8 row_mask:0xf bank_mask:0xf
    v_add_f32_dpp v152, v152, v152 row_ror:4 row_mask:0xf bank_mask:0xf
    v_add_f32_dpp v153, v153, v153 row_ror:4 row_mask:0xf bank_mask:0xf
    v_add_f32_dpp v154, v154, v154 row_ror:4 row_mask:0xf bank_mask:0xf
    v_add_f32_dpp v155, v155, v155 row_ror:4 row_mask:0xf bank_mask:0xf
    v_add_f32_dpp v152, v152, v152 row_ror:2 row_mask:0xf bank_mask:0xf
    v_add_f32_dpp v153, v153, v153 row_ror:2 row_mask:0xf bank_mask:0xf
    v_add_f32_dpp v154, v154, v154 row_ror:2 row_mask:0xf bank_mask:0xf
    v_add_f32_dpp v155, v155, v155 row_ror:2 row_mask:0xf bank_mask:0xf
    v_add_f32_dpp v152, v152, v152 row_ror:1 row_mask:0xf bank_mask:0xf
    v_add_f32_dpp v153, v153, v153 row_ror:1 row_mask:0xf bank_mask:0xf
    v_add_f32_dpp v154, v154, v154 row_ror:1 row_mask:0xf bank_mask:0xf
    v_add_f32_dpp v155, v155, v155 row_ror:1 row_mask:0xf bank_mask:0xf
    v_permlane16_swap_b32 v152, v153
    s_nop 0
    v_permlane16_swap_b32 v154, v155
    v_add_f32 v152, v152, v153
    v_add_f32 v154, v154, v155
    s_and_b32 s25, s24, 31
    s_lshr_b32 s25, s25, 1
    v_permlane32_swap_b32 v152, v154
    v_add_f32 v152, v152, v154
    s_andn2_b32 s24, s24, 31
    s_add_u32 s24, s24, s25
    s_lshl_b32 s24, s24, 2
    s_add_u32 s24, s24, 294912
    v_mul_f32 v152, 0xbfb8aa3b, v152
    v_exp_f32 v152, v152
    v_and_b32 v4, 1, v3
    v_lshlrev_b32 v4, 6, v4
    v_lshrrev_b32 v7, 1, v3
    v_lshl_add_u32 v4, v7, 2, v4
    v_add_f32 v152, 1.0, v152
    v_rcp_f32 v152, v152
    s_mov_b32 s36, 0x00010001
    s_mov_b32 s37, 0x00010001
    s_mov_b64 exec, s[36:37]
    buffer_store_dword v152, v4, s[12:15], s24 offen sc0 sc1
    s_mov_b64 exec, -1
    s_mov_b32 s31, 0
    v_add_u32 v12, s31, v5
    v_add_u32 v13, s31, v6
    v_add_u32 v14, s31, v8
    v_add_u32 v15, s31, v9
    v_add_u32 v16, s31, v10
    s_barrier
    ds_read_b64_tr_b16 v[176:177], v14 offset:8192
    ds_read_b64_tr_b16 v[178:179], v14 offset:8704
    ds_read_b64_tr_b16 v[180:181], v14 offset:16384
    ds_read_b64_tr_b16 v[182:183], v14 offset:16896
    ds_read_b64_tr_b16 v[172:173], v14 offset:0
    ds_read_b64_tr_b16 v[174:175], v14 offset:512
    ds_read_b128 v[132:135], v15
    ds_read_b128 v[136:139], v12 offset:4096
    ds_read_b128 v[156:159], v12 offset:6144
    ds_read_b128 v[140:143], v12 offset:8192
    ds_read_b128 v[160:163], v12 offset:10240
    ds_read_b128 v[144:147], v12 offset:12288
    ds_read_b128 v[164:167], v12 offset:14336
    ds_read_b128 v[148:151], v12 offset:16384
    ds_read_b128 v[168:171], v12 offset:18432
    s_mov_b32 s30, 0
.p2align 3
f_aloop:
    s_waitcnt lgkmcnt(0)
    v_mfma_f32_16x16x32_bf16 v[52:55], v[176:179], v[132:135], v[52:55]
    ds_read_b64_tr_b16 v[228:229], v14 offset:12288
    v_mfma_f32_16x16x32_bf16 v[92:95], v[132:135], v[180:183], v[92:95]
    ds_read_b64_tr_b16 v[230:231], v14 offset:12800
    v_mfma_f32_16x16x32_bf16 v[56:59], v[176:179], v[136:139], v[56:59]
    ds_read_b64_tr_b16 v[232:233], v14 offset:20480
    v_mfma_f32_16x16x32_bf16 v[96:99], v[136:139], v[180:183], v[96:99]
    ds_read_b64_tr_b16 v[234:235], v14 offset:20992
    v_mfma_f32_16x16x32_bf16 v[20:23], v[172:175], v[136:139], v[20:23]
    ds_read_b64_tr_b16 v[224:225], v14 offset:4096
    v_mfma_f32_16x16x32_bf16 v[76:79], v[176:179], v[156:159], v[76:79]
    ds_read_b64_tr_b16 v[226:227], v14 offset:4608
    v_mfma_f32_16x16x32_bf16 v[116:119], v[156:159], v[180:183], v[116:119]
    ds_read_b128 v[184:187], v16
    v_mfma_f32_16x16x32_bf16 v[36:39], v[172:175], v[156:159], v[36:39]
    ds_read_b128 v[188:191], v13 offset:4096
    v_mfma_f32_16x16x32_bf16 v[60:63], v[176:179], v[140:143], v[60:63]
    ds_read_b128 v[208:211], v13 offset:6144
    v_mfma_f32_16x16x32_bf16 v[100:103], v[140:143], v[180:183], v[100:103]
    ds_read_b128 v[192:195], v13 offset:8192
    v_mfma_f32_16x16x32_bf16 v[24:27], v[172:175], v[140:143], v[24:27]
    ds_read_b128 v[212:215], v13 offset:10240
    v_mfma_f32_16x16x32_bf16 v[80:83], v[176:179], v[160:163], v[80:83]
    ds_read_b128 v[196:199], v13 offset:12288
    v_mfma_f32_16x16x32_bf16 v[120:123], v[160:163], v[180:183], v[120:123]
    ds_read_b128 v[216:219], v13 offset:14336
    v_mfma_f32_16x16x32_bf16 v[40:43], v[172:175], v[160:163], v[40:43]
    ds_read_b128 v[200:203], v13 offset:16384
    v_mfma_f32_16x16x32_bf16 v[64:67], v[176:179], v[144:147], v[64:67]
    ds_read_b128 v[220:223], v13 offset:18432
    v_mfma_f32_16x16x32_bf16 v[104:107], v[144:147], v[180:183], v[104:107]
    s_add_u32 s31, s31, 45056
    s_cmp_eq_u32 s31, 135168
    v_mfma_f32_16x16x32_bf16 v[28:31], v[172:175], v[144:147], v[28:31]
    s_cselect_b32 s31, 0, s31
    v_add_u32 v12, s31, v5
    v_mfma_f32_16x16x32_bf16 v[84:87], v[176:179], v[164:167], v[84:87]
    v_add_u32 v13, s31, v6
    v_add_u32 v14, s31, v8
    v_mfma_f32_16x16x32_bf16 v[124:127], v[164:167], v[180:183], v[124:127]
    v_add_u32 v15, s31, v9
    v_add_u32 v16, s31, v10
    v_mfma_f32_16x16x32_bf16 v[44:47], v[172:175], v[164:167], v[44:47]
    s_add_u32 s30, s30, 1
    s_cmp_eq_u32 s30, 8
    v_mfma_f32_16x16x32_bf16 v[68:71], v[176:179], v[148:151], v[68:71]
    v_mfma_f32_16x16x32_bf16 v[108:111], v[148:151], v[180:183], v[108:111]
    v_mfma_f32_16x16x32_bf16 v[32:35], v[172:175], v[148:151], v[32:35]
    v_mfma_f32_16x16x32_bf16 v[88:91], v[176:179], v[168:171], v[88:91]
    v_mfma_f32_16x16x32_bf16 v[128:131], v[168:171], v[180:183], v[128:131]
    v_mfma_f32_16x16x32_bf16 v[48:51], v[172:175], v[168:171], v[48:51]
    s_waitcnt lgkmcnt(0)
    v_mfma_f32_16x16x32_bf16 v[52:55], v[228:231], v[184:187], v[52:55]
    s_barrier
    v_mfma_f32_16x16x32_bf16 v[92:95], v[184:187], v[232:235], v[92:95]
    ds_read_b64_tr_b16 v[176:177], v14 offset:8192
    v_mfma_f32_16x16x32_bf16 v[56:59], v[228:231], v[188:191], v[56:59]
    ds_read_b64_tr_b16 v[178:179], v14 offset:8704
    v_mfma_f32_16x16x32_bf16 v[96:99], v[188:191], v[232:235], v[96:99]
    ds_read_b64_tr_b16 v[180:181], v14 offset:16384
    v_mfma_f32_16x16x32_bf16 v[20:23], v[224:227], v[188:191], v[20:23]
    ds_read_b64_tr_b16 v[182:183], v14 offset:16896
    v_mfma_f32_16x16x32_bf16 v[76:79], v[228:231], v[208:211], v[76:79]
    ds_read_b64_tr_b16 v[172:173], v14 offset:0
    v_mfma_f32_16x16x32_bf16 v[116:119], v[208:211], v[232:235], v[116:119]
    ds_read_b64_tr_b16 v[174:175], v14 offset:512
    v_mfma_f32_16x16x32_bf16 v[36:39], v[224:227], v[208:211], v[36:39]
    ds_read_b128 v[132:135], v15
    v_mfma_f32_16x16x32_bf16 v[60:63], v[228:231], v[192:195], v[60:63]
    ds_read_b128 v[136:139], v12 offset:4096
    v_mfma_f32_16x16x32_bf16 v[100:103], v[192:195], v[232:235], v[100:103]
    ds_read_b128 v[156:159], v12 offset:6144
    v_mfma_f32_16x16x32_bf16 v[24:27], v[224:227], v[192:195], v[24:27]
    ds_read_b128 v[140:143], v12 offset:8192
    v_mfma_f32_16x16x32_bf16 v[80:83], v[228:231], v[212:215], v[80:83]
    ds_read_b128 v[160:163], v12 offset:10240
    v_mfma_f32_16x16x32_bf16 v[120:123], v[212:215], v[232:235], v[120:123]
    ds_read_b128 v[144:147], v12 offset:12288
    v_mfma_f32_16x16x32_bf16 v[40:43], v[224:227], v[212:215], v[40:43]
    ds_read_b128 v[164:167], v12 offset:14336
    v_mfma_f32_16x16x32_bf16 v[64:67], v[228:231], v[196:199], v[64:67]
    ds_read_b128 v[148:151], v12 offset:16384
    v_mfma_f32_16x16x32_bf16 v[104:107], v[196:199], v[232:235], v[104:107]
    ds_read_b128 v[168:171], v12 offset:18432
    v_mfma_f32_16x16x32_bf16 v[28:31], v[224:227], v[196:199], v[28:31]
    v_mfma_f32_16x16x32_bf16 v[84:87], v[228:231], v[216:219], v[84:87]
    v_mfma_f32_16x16x32_bf16 v[124:127], v[216:219], v[232:235], v[124:127]
    v_mfma_f32_16x16x32_bf16 v[44:47], v[224:227], v[216:219], v[44:47]
    v_mfma_f32_16x16x32_bf16 v[68:71], v[228:231], v[200:203], v[68:71]
    v_mfma_f32_16x16x32_bf16 v[108:111], v[200:203], v[232:235], v[108:111]
    v_mfma_f32_16x16x32_bf16 v[32:35], v[224:227], v[200:203], v[32:35]
    v_mfma_f32_16x16x32_bf16 v[88:91], v[228:231], v[220:223], v[88:91]
    v_mfma_f32_16x16x32_bf16 v[128:131], v[220:223], v[232:235], v[128:131]
    v_mfma_f32_16x16x32_bf16 v[48:51], v[224:227], v[220:223], v[48:51]
    s_cbranch_scc0 f_aloop
    s_waitcnt lgkmcnt(0)
    v_mov_b32 v222, 0
    global_load_dwordx2 v[224:225], v222, s[84:85] sc0 sc1
    s_cmp_eq_u32 s21, 0
    s_cselect_b64 s[36:37], 0, -1
    v_cndmask_b32 v188, v18, v240, s[36:37]
    v_mov_b32 v192, 0x3f803f80
    v_cndmask_b32 v189, v18, v241, s[36:37]
    v_mov_b32 v193, 0x3f803f80
    v_cndmask_b32 v190, v18, v242, s[36:37]
    v_mov_b32 v194, 0x3f803f80
    v_cndmask_b32 v191, v18, v243, s[36:37]
    v_mov_b32 v195, 0x3f803f80
    v_cvt_pk_bf16_f32 v148, v52, v53
    v_cvt_pk_bf16_f32 v149, v54, v55
    v_cvt_pk_bf16_f32 v168, v92, v93
    v_cvt_pk_bf16_f32 v169, v94, v95
    v_cvt_pk_bf16_f32 v132, v20, v21
    v_cvt_pk_bf16_f32 v133, v22, v23
    v_cvt_pk_bf16_f32 v150, v56, v57
    v_cvt_pk_bf16_f32 v151, v58, v59
    v_cvt_pk_bf16_f32 v170, v96, v97
    v_cvt_pk_bf16_f32 v171, v98, v99
    v_cvt_pk_bf16_f32 v134, v24, v25
    v_cvt_pk_bf16_f32 v135, v26, v27
    v_cvt_pk_bf16_f32 v152, v60, v61
    v_cvt_pk_bf16_f32 v153, v62, v63
    v_cvt_pk_bf16_f32 v172, v100, v101
    v_cvt_pk_bf16_f32 v173, v102, v103
    v_cvt_pk_bf16_f32 v136, v28, v29
    v_cvt_pk_bf16_f32 v137, v30, v31
    v_cvt_pk_bf16_f32 v154, v64, v65
    v_cvt_pk_bf16_f32 v155, v66, v67
    v_cvt_pk_bf16_f32 v174, v104, v105
    v_cvt_pk_bf16_f32 v175, v106, v107
    v_cvt_pk_bf16_f32 v138, v32, v33
    v_cvt_pk_bf16_f32 v139, v34, v35
    v_cvt_pk_bf16_f32 v156, v68, v69
    v_cvt_pk_bf16_f32 v157, v70, v71
    v_cvt_pk_bf16_f32 v176, v108, v109
    v_cvt_pk_bf16_f32 v177, v110, v111
    v_cvt_pk_bf16_f32 v140, v36, v37
    v_cvt_pk_bf16_f32 v141, v38, v39
    v_cvt_pk_bf16_f32 v158, v52, v53
    v_cvt_pk_bf16_f32 v159, v54, v55
    v_cvt_pk_bf16_f32 v178, v92, v93
    v_cvt_pk_bf16_f32 v179, v94, v95
    v_cvt_pk_bf16_f32 v142, v40, v41
    v_cvt_pk_bf16_f32 v143, v42, v43
    v_cvt_pk_bf16_f32 v160, v76, v77
    v_cvt_pk_bf16_f32 v161, v78, v79
    v_cvt_pk_bf16_f32 v180, v116, v117
    v_cvt_pk_bf16_f32 v181, v118, v119
    v_cvt_pk_bf16_f32 v144, v44, v45
    v_cvt_pk_bf16_f32 v145, v46, v47
    v_cvt_pk_bf16_f32 v162, v80, v81
    v_cvt_pk_bf16_f32 v163, v82, v83
    v_cvt_pk_bf16_f32 v182, v120, v121
    v_cvt_pk_bf16_f32 v183, v122, v123
    v_cvt_pk_bf16_f32 v146, v48, v49
    v_cvt_pk_bf16_f32 v147, v50, v51
    v_cvt_pk_bf16_f32 v164, v84, v85
    v_cvt_pk_bf16_f32 v165, v86, v87
    v_cvt_pk_bf16_f32 v184, v124, v125
    v_cvt_pk_bf16_f32 v185, v126, v127
    v_cvt_pk_bf16_f32 v166, v88, v89
    v_cvt_pk_bf16_f32 v167, v90, v91
    v_cvt_pk_bf16_f32 v186, v128, v129
    v_cvt_pk_bf16_f32 v187, v130, v131
    v_mfma_f32_16x16x16_bf16 v[20:23], v[150:151], v[132:133], v[236:239]
    v_mfma_f32_16x16x16_bf16 v[52:55], v[148:149], v[132:133], v[72:75]
    v_mfma_f32_16x16x16_bf16 v[24:27], v[152:153], v[134:135], v[236:239]
    v_mfma_f32_16x16x16_bf16 v[56:59], v[150:151], v[134:135], v[240:243]
    v_mfma_f32_16x16x16_bf16 v[28:31], v[154:155], v[136:137], v[236:239]
    v_mfma_f32_16x16x16_bf16 v[60:63], v[152:153], v[136:137], v[240:243]
    v_mfma_f32_16x16x16_bf16 v[32:35], v[156:157], v[138:139], v[236:239]
    v_mfma_f32_16x16x16_bf16 v[64:67], v[154:155], v[138:139], v[240:243]
    v_mfma_f32_16x16x16_bf16 v[36:39], v[160:161], v[140:141], v[236:239]
    v_mfma_f32_16x16x16_bf16 v[68:71], v[158:159], v[140:141], v[188:191]
    v_mfma_f32_16x16x16_bf16 v[40:43], v[162:163], v[142:143], v[236:239]
    v_mfma_f32_16x16x16_bf16 v[72:75], v[160:161], v[142:143], v[240:243]
    v_mfma_f32_16x16x16_bf16 v[44:47], v[164:165], v[144:145], v[236:239]
    v_mfma_f32_16x16x16_bf16 v[76:79], v[162:163], v[144:145], v[240:243]
    v_mfma_f32_16x16x16_bf16 v[48:51], v[166:167], v[146:147], v[236:239]
    v_mfma_f32_16x16x16_bf16 v[80:83], v[164:165], v[146:147], v[240:243]
    s_mov_b32 s32, 0x3eb8aa3b
    v_max_f32 v20, v20, v52
    v_max_f32 v21, v21, v53
    v_max_f32 v22, v22, v54
    v_max_f32 v23, v23, v55
    v_max_f32 v24, v24, v56
    v_max_f32 v25, v25, v57
    v_max_f32 v26, v26, v58
    v_max_f32 v27, v27, v59
    v_max_f32 v28, v28, v60
    v_max_f32 v29, v29, v61
    v_max_f32 v30, v30, v62
    v_max_f32 v31, v31, v63
    v_max_f32 v32, v32, v64
    v_max_f32 v33, v33, v65
    v_max_f32 v34, v34, v66
    v_max_f32 v35, v35, v67
    v_max_f32 v36, v36, v68
    v_max_f32 v37, v37, v69
    v_max_f32 v38, v38, v70
    v_max_f32 v39, v39, v71
    v_max_f32 v40, v40, v72
    v_max_f32 v41, v41, v73
    v_max_f32 v42, v42, v74
    v_max_f32 v43, v43, v75
    v_max_f32 v44, v44, v76
    v_max_f32 v45, v45, v77
    v_max_f32 v46, v46, v78
    v_max_f32 v47, v47, v79
    v_max_f32 v48, v48, v80
    v_max_f32 v49, v49, v81
    v_max_f32 v50, v50, v82
    v_max_f32 v51, v51, v83
    v_max3_f32 v196, v20, v21, v22
    v_max3_f32 v197, v24, v25, v26
    v_max3_f32 v198, v28, v29, v30
    v_max3_f32 v199, v32, v33, v34
    v_max3_f32 v200, v36, v37, v38
    v_max3_f32 v201, v40, v41, v42
    v_max3_f32 v202, v44, v45, v46
    v_max3_f32 v203, v48, v49, v50
    v_max_f32 v196, v196, v23
    v_max_f32 v197, v197, v27
    v_max_f32 v198, v198, v31
    v_max_f32 v199, v199, v35
    v_max_f32 v200, v200, v39
    v_max_f32 v201, v201, v43
    v_max_f32 v202, v202, v47
    v_max_f32 v203, v203, v51
    v_mov_b32 v204, v196
    v_mov_b32 v205, v197
    v_mov_b32 v206, v198
    v_mov_b32 v207, v199
    v_mov_b32 v208, v200
    v_mov_b32 v209, v201
    v_mov_b32 v210, v202
    v_mov_b32 v211, v203
    v_permlane16_swap_b32 v196, v204
    v_permlane16_swap_b32 v197, v205
    v_permlane16_swap_b32 v198, v206
    v_permlane16_swap_b32 v199, v207
    v_permlane16_swap_b32 v200, v208
    v_permlane16_swap_b32 v201, v209
    v_permlane16_swap_b32 v202, v210
    v_permlane16_swap_b32 v203, v211
    v_max_f32 v196, v196, v204
    v_max_f32 v197, v197, v205
    v_max_f32 v198, v198, v206
    v_max_f32 v199, v199, v207
    v_max_f32 v200, v200, v208
    v_max_f32 v201, v201, v209
    v_max_f32 v202, v202, v210
    v_max_f32 v203, v203, v211
    v_mov_b32 v204, v196
    v_mov_b32 v205, v197
    v_mov_b32 v206, v198
    v_mov_b32 v207, v199
    v_mov_b32 v208, v200
    v_mov_b32 v209, v201
    v_mov_b32 v210, v202
    v_mov_b32 v211, v203
    v_permlane32_swap_b32 v196, v204
    v_permlane32_swap_b32 v197, v205
    v_permlane32_swap_b32 v198, v206
    v_permlane32_swap_b32 v199, v207
    v_permlane32_swap_b32 v200, v208
    v_permlane32_swap_b32 v201, v209
    v_permlane32_swap_b32 v202, v210
    v_permlane32_swap_b32 v203, v211
    v_max_f32 v196, v196, v204
    v_max_f32 v197, v197, v205
    v_max_f32 v198, v198, v206
    v_max_f32 v199, v199, v207
    v_max_f32 v200, v200, v208
    v_max_f32 v201, v201, v209
    v_max_f32 v202, v202, v210
    v_max_f32 v203, v203, v211
    v_mul_f32 v196, s32, v196
    v_mul_f32 v197, s32, v197
    v_mul_f32 v198, s32, v198
    v_mul_f32 v199, s32, v199
    v_mul_f32 v200, s32, v200
    v_mul_f32 v201, s32, v201
    v_mul_f32 v202, s32, v202
    v_mul_f32 v203, s32, v203
    v_fma_f32 v20, v20, s32, -v196
    v_fma_f32 v21, v21, s32, -v196
    v_fma_f32 v22, v22, s32, -v196
    v_fma_f32 v23, v23, s32, -v196
    v_fma_f32 v24, v24, s32, -v197
    v_fma_f32 v25, v25, s32, -v197
    v_fma_f32 v26, v26, s32, -v197
    v_fma_f32 v27, v27, s32, -v197
    v_fma_f32 v28, v28, s32, -v198
    v_fma_f32 v29, v29, s32, -v198
    v_fma_f32 v30, v30, s32, -v198
    v_fma_f32 v31, v31, s32, -v198
    v_fma_f32 v32, v32, s32, -v199
    v_fma_f32 v33, v33, s32, -v199
    v_fma_f32 v34, v34, s32, -v199
    v_fma_f32 v35, v35, s32, -v199
    v_fma_f32 v36, v36, s32, -v200
    v_fma_f32 v37, v37, s32, -v200
    v_fma_f32 v38, v38, s32, -v200
    v_fma_f32 v39, v39, s32, -v200
    v_fma_f32 v40, v40, s32, -v201
    v_fma_f32 v41, v41, s32, -v201
    v_fma_f32 v42, v42, s32, -v201
    v_fma_f32 v43, v43, s32, -v201
    v_fma_f32 v44, v44, s32, -v202
    v_fma_f32 v45, v45, s32, -v202
    v_fma_f32 v46, v46, s32, -v202
    v_fma_f32 v47, v47, s32, -v202
    v_fma_f32 v48, v48, s32, -v203
    v_fma_f32 v49, v49, s32, -v203
    v_fma_f32 v50, v50, s32, -v203
    v_fma_f32 v51, v51, s32, -v203
    v_exp_f32 v20, v20
    v_exp_f32 v21, v21
    v_exp_f32 v22, v22
    v_exp_f32 v23, v23
    v_exp_f32 v24, v24
    v_exp_f32 v25, v25
    v_exp_f32 v26, v26
    v_exp_f32 v27, v27
    v_exp_f32 v28, v28
    v_exp_f32 v29, v29
    v_exp_f32 v30, v30
    v_exp_f32 v31, v31
    v_exp_f32 v32, v32
    v_exp_f32 v33, v33
    v_exp_f32 v34, v34
    v_exp_f32 v35, v35
    v_exp_f32 v36, v36
    v_exp_f32 v37, v37
    v_exp_f32 v38, v38
    v_exp_f32 v39, v39
    v_exp_f32 v40, v40
    v_exp_f32 v41, v41
    v_exp_f32 v42, v42
    v_exp_f32 v43, v43
    v_exp_f32 v44, v44
    v_exp_f32 v45, v45
    v_exp_f32 v46, v46
    v_exp_f32 v47, v47
    v_exp_f32 v48, v48
    v_exp_f32 v49, v49
    v_exp_f32 v50, v50
    v_exp_f32 v51, v51
    v_cvt_pk_bf16_f32 v52, v20, v21
    v_cvt_pk_bf16_f32 v53, v22, v23
    v_cvt_pk_bf16_f32 v54, v24, v25
    v_cvt_pk_bf16_f32 v55, v26, v27
    v_cvt_pk_bf16_f32 v56, v28, v29
    v_cvt_pk_bf16_f32 v57, v30, v31
    v_cvt_pk_bf16_f32 v58, v32, v33
    v_cvt_pk_bf16_f32 v59, v34, v35
    v_cvt_pk_bf16_f32 v60, v36, v37
    v_cvt_pk_bf16_f32 v61, v38, v39
    v_cvt_pk_bf16_f32 v62, v40, v41
    v_cvt_pk_bf16_f32 v63, v42, v43
    v_cvt_pk_bf16_f32 v64, v44, v45
    v_cvt_pk_bf16_f32 v65, v46, v47
    v_cvt_pk_bf16_f32 v66, v48, v49
    v_cvt_pk_bf16_f32 v67, v50, v51
    v_and_b32 v84, v246, v52
    v_and_b32 v86, v244, v52
    v_and_b32 v85, v247, v53
    v_and_b32 v87, v245, v53
    v_and_b32 v88, v246, v54
    v_and_b32 v90, v244, v54
    v_and_b32 v89, v247, v55
    v_and_b32 v91, v245, v55
    v_and_b32 v92, v246, v56
    v_and_b32 v94, v244, v56
    v_and_b32 v93, v247, v57
    v_and_b32 v95, v245, v57
    v_and_b32 v96, v246, v58
    v_and_b32 v98, v244, v58
    v_and_b32 v97, v247, v59
    v_and_b32 v99, v245, v59
    v_and_b32 v100, v246, v60
    v_and_b32 v102, v244, v60
    v_and_b32 v101, v247, v61
    v_and_b32 v103, v245, v61
    v_and_b32 v104, v246, v62
    v_and_b32 v106, v244, v62
    v_and_b32 v105, v247, v63
    v_and_b32 v107, v245, v63
    v_and_b32 v108, v246, v64
    v_and_b32 v110, v244, v64
    v_and_b32 v109, v247, v65
    v_and_b32 v111, v245, v65
    v_and_b32 v112, v246, v66
    v_and_b32 v114, v244, v66
    v_and_b32 v113, v247, v67
    v_and_b32 v115, v245, v67
    v_mfma_f32_16x16x32_bf16 v[52:55], v[192:195], v[84:87], 0
    v_mfma_f32_16x16x32_bf16 v[20:23], v[168:171], v[84:87], 0
    v_mfma_f32_16x16x32_bf16 v[56:59], v[192:195], v[88:91], 0
    v_mfma_f32_16x16x32_bf16 v[24:27], v[170:173], v[88:91], 0
    v_mfma_f32_16x16x32_bf16 v[60:63], v[192:195], v[92:95], 0
    v_mfma_f32_16x16x32_bf16 v[28:31], v[172:175], v[92:95], 0
    v_mfma_f32_16x16x32_bf16 v[64:67], v[192:195], v[96:99], 0
    v_mfma_f32_16x16x32_bf16 v[32:35], v[174:177], v[96:99], 0
    v_mfma_f32_16x16x32_bf16 v[68:71], v[192:195], v[100:103], 0
    v_mfma_f32_16x16x32_bf16 v[36:39], v[178:181], v[100:103], 0
    v_mfma_f32_16x16x32_bf16 v[72:75], v[192:195], v[104:107], 0
    v_mfma_f32_16x16x32_bf16 v[40:43], v[180:183], v[104:107], 0
    v_mfma_f32_16x16x32_bf16 v[76:79], v[192:195], v[108:111], 0
    v_mfma_f32_16x16x32_bf16 v[44:47], v[182:185], v[108:111], 0
    v_mfma_f32_16x16x32_bf16 v[80:83], v[192:195], v[112:115], 0
    v_mfma_f32_16x16x32_bf16 v[48:51], v[184:187], v[112:115], 0
    s_lshl_b32 s34, s21, 7
    s_lshl_b32 s35, s22, 2
    s_add_u32 s34, s34, s35
    s_add_u32 s34, s34, s29
    s_lshl_b32 s34, s34, 10
    s_add_u32 s34, s34, 4194304
    v_lshlrev_b32 v4, 4, v1
    s_mov_b32 s47, 0
tag_71w:
    s_waitcnt vmcnt(0)
    v_readfirstlane_b32 s62, v224
    v_readfirstlane_b32 s63, v225
    s_add_u32 s47, s47, 1
    s_cmp_lg_u32 s62, 0
    s_cbranch_scc1 tag_71k
    global_load_dwordx2 v[224:225], v222, s[84:85] sc0 sc1
    s_cmp_lt_u32 s47, 0x40000
    s_cbranch_scc1 tag_71w
tag_71k:
    v_rcp_f32 v52, v52
    v_rcp_f32 v56, v56
    v_rcp_f32 v60, v60
    v_rcp_f32 v64, v64
    v_rcp_f32 v68, v68
    v_rcp_f32 v72, v72
    v_rcp_f32 v76, v76
    v_rcp_f32 v80, v80
    v_pk_mul_f32 v[20:21], v[20:21], v[52:53] op_sel_hi:[1,0]
    v_pk_mul_f32 v[22:23], v[22:23], v[52:53] op_sel_hi:[1,0]
    v_pk_mul_f32 v[36:37], v[36:37], v[68:69] op_sel_hi:[1,0]
    v_pk_mul_f32 v[38:39], v[38:39], v[68:69] op_sel_hi:[1,0]
    v_cvt_pk_bf16_f32 v84, v20, v21
    v_cvt_pk_bf16_f32 v85, v22, v23
    v_cvt_pk_bf16_f32 v86, v36, v37
    v_cvt_pk_bf16_f32 v87, v38, v39
    s_add_u32 s35, s34, 0
    buffer_store_dwordx4 v[84:87], v4, s[12:15], s35 offen sc0 sc1
    v_pk_mul_f32 v[24:25], v[24:25], v[56:57] op_sel_hi:[1,0]
    v_pk_mul_f32 v[26:27], v[26:27], v[56:57] op_sel_hi:[1,0]
    v_pk_mul_f32 v[40:41], v[40:41], v[72:73] op_sel_hi:[1,0]
    v_pk_mul_f32 v[42:43], v[42:43], v[72:73] op_sel_hi:[1,0]
    v_cvt_pk_bf16_f32 v88, v24, v25
    v_cvt_pk_bf16_f32 v89, v26, v27
    v_cvt_pk_bf16_f32 v90, v40, v41
    v_cvt_pk_bf16_f32 v91, v42, v43
    s_add_u32 s35, s34, 32768
    buffer_store_dwordx4 v[88:91], v4, s[12:15], s35 offen sc0 sc1
    v_pk_mul_f32 v[28:29], v[28:29], v[60:61] op_sel_hi:[1,0]
    v_pk_mul_f32 v[30:31], v[30:31], v[60:61] op_sel_hi:[1,0]
    v_pk_mul_f32 v[44:45], v[44:45], v[76:77] op_sel_hi:[1,0]
    v_pk_mul_f32 v[46:47], v[46:47], v[76:77] op_sel_hi:[1,0]
    v_cvt_pk_bf16_f32 v92, v28, v29
    v_cvt_pk_bf16_f32 v93, v30, v31
    v_cvt_pk_bf16_f32 v94, v44, v45
    v_cvt_pk_bf16_f32 v95, v46, v47
    s_add_u32 s35, s34, 65536
    buffer_store_dwordx4 v[92:95], v4, s[12:15], s35 offen sc0 sc1
    v_pk_mul_f32 v[32:33], v[32:33], v[64:65] op_sel_hi:[1,0]
    v_pk_mul_f32 v[34:35], v[34:35], v[64:65] op_sel_hi:[1,0]
    v_pk_mul_f32 v[48:49], v[48:49], v[80:81] op_sel_hi:[1,0]
    v_pk_mul_f32 v[50:51], v[50:51], v[80:81] op_sel_hi:[1,0]
    v_cvt_pk_bf16_f32 v96, v32, v33
    v_cvt_pk_bf16_f32 v97, v34, v35
    v_cvt_pk_bf16_f32 v98, v48, v49
    v_cvt_pk_bf16_f32 v99, v50, v51
    s_add_u32 s35, s34, 98304
    buffer_store_dwordx4 v[96:99], v4, s[12:15], s35 offen sc0 sc1
    s_lshl_b32 s34, s21, 5
    s_lshl_b32 s35, s22, 2
    s_add_u32 s34, s34, s35
    s_add_u32 s34, s34, s29
    s_lshl_b32 s34, s34, 3
    s_add_u32 s50, s34, 270336
    s_lshl_b32 s24, s29, 12
    v_add_u32 v5, s24, v5
    v_add_u32 v6, s24, v6
    v_mov_b32 v238, 0
    v_mov_b32 v240, 0
    s_mov_b32 s51, 14
    v_mov_b32 v244, s62
    v_mov_b32 v245, s63
    s_waitcnt vmcnt(0)
    s_mov_b64 exec, 1
    buffer_store_dwordx2 v[244:245], off, s[12:15], s50 sc0 sc1
    s_mov_b64 exec, -1
f_join:
    v_lshlrev_b32 v4, 4, v1
    v_pk_mov_b32 v[20:21], v[238:239], v[238:239]
    v_pk_mov_b32 v[22:23], v[238:239], v[238:239]
    v_pk_mov_b32 v[24:25], v[238:239], v[238:239]
    v_pk_mov_b32 v[26:27], v[238:239], v[238:239]
    v_pk_mov_b32 v[28:29], v[238:239], v[238:239]
    v_pk_mov_b32 v[30:31], v[238:239], v[238:239]
    v_pk_mov_b32 v[32:33], v[238:239], v[238:239]
    v_pk_mov_b32 v[34:35], v[238:239], v[238:239]
    v_pk_mov_b32 v[36:37], v[238:239], v[238:239]
    v_pk_mov_b32 v[38:39], v[238:239], v[238:239]
    v_pk_mov_b32 v[40:41], v[238:239], v[238:239]
    v_pk_mov_b32 v[42:43], v[238:239], v[238:239]
    v_pk_mov_b32 v[44:45], v[238:239], v[238:239]
    v_pk_mov_b32 v[46:47], v[238:239], v[238:239]
    v_pk_mov_b32 v[48:49], v[240:241], v[240:241]
    v_pk_mov_b32 v[50:51], v[240:241], v[240:241]
    v_pk_mov_b32 v[52:53], v[240:241], v[240:241]
    v_pk_mov_b32 v[54:55], v[240:241], v[240:241]
    v_pk_mov_b32 v[56:57], v[240:241], v[240:241]
    v_pk_mov_b32 v[58:59], v[240:241], v[240:241]
    v_pk_mov_b32 v[60:61], v[240:241], v[240:241]
    v_pk_mov_b32 v[62:63], v[240:241], v[240:241]
    v_pk_mov_b32 v[64:65], v[240:241], v[240:241]
    v_pk_mov_b32 v[66:67], v[240:241], v[240:241]
    v_pk_mov_b32 v[68:69], v[240:241], v[240:241]
    v_pk_mov_b32 v[70:71], v[240:241], v[240:241]
    v_pk_mov_b32 v[72:73], v[240:241], v[240:241]
    v_pk_mov_b32 v[74:75], v[240:241], v[240:241]
    s_mov_b32 s31, 131072
    s_mov_b32 s46, 0
    s_lshl_b32 s34, s21, 1
    s_lshr_b32 s35, s29, 1
    s_add_u32 s34, s34, s35
    s_lshl_b32 s34, s34, 3
    s_add_u32 s34, s34, s22
    s_lshl_b32 s34, s34, 1
    s_and_b32 s35, s29, 1
    s_add_u32 s34, s34, s35
    s_lshl_b32 s35, s21, 5
    s_lshl_b32 s36, s22, 2
    s_add_u32 s35, s35, s36
    s_add_u32 s35, s35, s29
    s_lshl_b32 s36, s34, 3
    s_add_u32 s36, s36, 274432
    s_mul_i32 s34, s34, 7168
    s_add_u32 s34, s34, 6291456
    s_mul_i32 s52, s35, 10240
    s_add_u32 s52, s52, 13107200
    s_add_u32 s53, s52, 4096
    s_add_u32 s54, s52, 8192
    s_add_u32 s35, s34, 4096
    v_add_u32 v12, s31, v5
    v_add_u32 v13, s31, v6
    v_add_u32 v14, s46, v4
    s_barrier
    ds_read_b128 v[132:135], v12 offset:0
    ds_read_b128 v[136:139], v12 offset:2048
    ds_read_b128 v[140:143], v14 offset:0
    ds_read_b128 v[144:147], v14 offset:1024
    ds_read_b128 v[148:151], v14 offset:2048
    ds_read_b128 v[152:155], v14 offset:3072
    ds_read_b128 v[156:159], v14 offset:4096
    ds_read_b128 v[160:163], v14 offset:5120
    ds_read_b128 v[164:167], v14 offset:6144
    s_mov_b32 s30, 0
.p2align 3
f_g2loop:
    s_waitcnt lgkmcnt(3)
    v_mfma_f32_16x16x32_bf16 v[20:23], v[140:143], v[132:135], v[20:23]
    ds_read_b128 v[168:171], v13 offset:0
    v_mfma_f32_16x16x32_bf16 v[48:51], v[140:143], v[136:139], v[48:51]
    ds_read_b128 v[172:175], v13 offset:2048
    v_mfma_f32_16x16x32_bf16 v[24:27], v[144:147], v[132:135], v[24:27]
    ds_read_b128 v[176:179], v14 offset:7168
    v_mfma_f32_16x16x32_bf16 v[52:55], v[144:147], v[136:139], v[52:55]
    ds_read_b128 v[180:183], v14 offset:8192
    v_mfma_f32_16x16x32_bf16 v[28:31], v[148:151], v[132:135], v[28:31]
    ds_read_b128 v[184:187], v14 offset:9216
    v_mfma_f32_16x16x32_bf16 v[56:59], v[148:151], v[136:139], v[56:59]
    ds_read_b128 v[188:191], v14 offset:10240
    v_mfma_f32_16x16x32_bf16 v[32:35], v[152:155], v[132:135], v[32:35]
    ds_read_b128 v[192:195], v14 offset:11264
    v_mfma_f32_16x16x32_bf16 v[60:63], v[152:155], v[136:139], v[60:63]
    ds_read_b128 v[196:199], v14 offset:12288
    s_waitcnt lgkmcnt(6)
    v_mfma_f32_16x16x32_bf16 v[36:39], v[156:159], v[132:135], v[36:39]
    ds_read_b128 v[200:203], v14 offset:13312
    v_mfma_f32_16x16x32_bf16 v[64:67], v[156:159], v[136:139], v[64:67]
    s_add_u32 s31, s31, 16384
    s_cmp_eq_u32 s31, 163840
    v_mfma_f32_16x16x32_bf16 v[40:43], v[160:163], v[132:135], v[40:43]
    s_cselect_b32 s31, 65536, s31
    s_add_u32 s46, s46, 16384
    v_mfma_f32_16x16x32_bf16 v[68:71], v[160:163], v[136:139], v[68:71]
    s_and_b32 s46, s46, 0xffff
    v_add_u32 v12, s31, v5
    v_mfma_f32_16x16x32_bf16 v[44:47], v[164:167], v[132:135], v[44:47]
    v_add_u32 v13, s31, v6
    v_add_u32 v14, s46, v4
    v_mfma_f32_16x16x32_bf16 v[72:75], v[164:167], v[136:139], v[72:75]
    s_add_u32 s30, s30, 1
    s_cmp_eq_u32 s30, s51
    s_waitcnt lgkmcnt(1)
    v_mfma_f32_16x16x32_bf16 v[20:23], v[176:179], v[168:171], v[20:23]
    v_mfma_f32_16x16x32_bf16 v[48:51], v[176:179], v[172:175], v[48:51]
    s_waitcnt lgkmcnt(0)
    s_barrier
    v_mfma_f32_16x16x32_bf16 v[24:27], v[180:183], v[168:171], v[24:27]
    ds_read_b128 v[132:135], v12 offset:0
    v_mfma_f32_16x16x32_bf16 v[52:55], v[180:183], v[172:175], v[52:55]
    ds_read_b128 v[136:139], v12 offset:2048
    v_mfma_f32_16x16x32_bf16 v[28:31], v[184:187], v[168:171], v[28:31]
    ds_read_b128 v[140:143], v14 offset:0
    v_mfma_f32_16x16x32_bf16 v[56:59], v[184:187], v[172:175], v[56:59]
    ds_read_b128 v[144:147], v14 offset:1024
    v_mfma_f32_16x16x32_bf16 v[32:35], v[188:191], v[168:171], v[32:35]
    ds_read_b128 v[148:151], v14 offset:2048
    v_mfma_f32_16x16x32_bf16 v[60:63], v[188:191], v[172:175], v[60:63]
    ds_read_b128 v[152:155], v14 offset:3072
    v_mfma_f32_16x16x32_bf16 v[36:39], v[192:195], v[168:171], v[36:39]
    ds_read_b128 v[156:159], v14 offset:4096
    v_mfma_f32_16x16x32_bf16 v[64:67], v[192:195], v[172:175], v[64:67]
    ds_read_b128 v[160:163], v14 offset:5120
    v_mfma_f32_16x16x32_bf16 v[40:43], v[196:199], v[168:171], v[40:43]
    ds_read_b128 v[164:167], v14 offset:6144
    v_mfma_f32_16x16x32_bf16 v[68:71], v[196:199], v[172:175], v[68:71]
    v_mfma_f32_16x16x32_bf16 v[44:47], v[200:203], v[168:171], v[44:47]
    v_mfma_f32_16x16x32_bf16 v[72:75], v[200:203], v[172:175], v[72:75]
    s_cbranch_scc0 f_g2loop
    s_waitcnt lgkmcnt(0)
    s_cmp_eq_u32 s27, 0
    s_cbranch_scc1 f_hepi
    v_cvt_pk_bf16_f32 v132, v20, v21
    v_cvt_pk_bf16_f32 v133, v22, v23
    v_cvt_pk_bf16_f32 v134, v60, v61
    v_mov_b32 v135, s62
    buffer_store_dwordx4 v[132:135], v4, s[12:15], s52 offen offset:0 sc0 sc1
    v_cvt_pk_bf16_f32 v136, v24, v25
    v_cvt_pk_bf16_f32 v137, v26, v27
    v_cvt_pk_bf16_f32 v138, v62, v63
    v_mov_b32 v139, s62
    buffer_store_dwordx4 v[136:139], v4, s[12:15], s52 offen offset:1024 sc0 sc1
    v_cvt_pk_bf16_f32 v140, v28, v29
    v_cvt_pk_bf16_f32 v141, v30, v31
    v_cvt_pk_bf16_f32 v142, v64, v65
    v_mov_b32 v143, s62
    buffer_store_dwordx4 v[140:143], v4, s[12:15], s52 offen offset:2048 sc0 sc1
    v_cvt_pk_bf16_f32 v144, v32, v33
    v_cvt_pk_bf16_f32 v145, v34, v35
    v_cvt_pk_bf16_f32 v146, v66, v67
    v_mov_b32 v147, s62
    buffer_store_dwordx4 v[144:147], v4, s[12:15], s52 offen offset:3072 sc0 sc1
    v_cvt_pk_bf16_f32 v148, v36, v37
    v_cvt_pk_bf16_f32 v149, v38, v39
    v_cvt_pk_bf16_f32 v150, v68, v69
    v_mov_b32 v151, s62
    buffer_store_dwordx4 v[148:151], v4, s[12:15], s53 offen offset:0 sc0 sc1
    v_cvt_pk_bf16_f32 v152, v40, v41
    v_cvt_pk_bf16_f32 v153, v42, v43
    v_cvt_pk_bf16_f32 v154, v70, v71
    v_mov_b32 v155, s62
    buffer_store_dwordx4 v[152:155], v4, s[12:15], s53 offen offset:1024 sc0 sc1
    v_cvt_pk_bf16_f32 v156, v44, v45
    v_cvt_pk_bf16_f32 v157, v46, v47
    v_cvt_pk_bf16_f32 v158, v72, v73
    v_mov_b32 v159, s62
    buffer_store_dwordx4 v[156:159], v4, s[12:15], s53 offen offset:2048 sc0 sc1
    v_cvt_pk_bf16_f32 v160, v48, v49
    v_cvt_pk_bf16_f32 v161, v50, v51
    v_cvt_pk_bf16_f32 v162, v74, v75
    v_mov_b32 v163, s62
    buffer_store_dwordx4 v[160:163], v4, s[12:15], s53 offen offset:3072 sc0 sc1
    v_cvt_pk_bf16_f32 v164, v52, v53
    v_cvt_pk_bf16_f32 v165, v54, v55
    v_mov_b32 v167, s62
    buffer_store_dwordx4 v[164:167], v4, s[12:15], s54 offen offset:0 sc0 sc1
    v_cvt_pk_bf16_f32 v168, v56, v57
    v_cvt_pk_bf16_f32 v169, v58, v59
    v_mov_b32 v171, s62
    buffer_store_dwordx4 v[168:171], v4, s[12:15], s54 offen offset:1024 sc0 sc1
    s_branch f_e2
f_hepi:
    buffer_load_dwordx4 v[132:135], v4, s[12:15], s52 offen offset:0 sc0 sc1
    buffer_load_dwordx4 v[136:139], v4, s[12:15], s52 offen offset:1024 sc0 sc1
    buffer_load_dwordx4 v[140:143], v4, s[12:15], s52 offen offset:2048 sc0 sc1
    buffer_load_dwordx4 v[144:147], v4, s[12:15], s52 offen offset:3072 sc0 sc1
    buffer_load_dwordx4 v[148:151], v4, s[12:15], s53 offen offset:0 sc0 sc1
    buffer_load_dwordx4 v[152:155], v4, s[12:15], s53 offen offset:1024 sc0 sc1
    buffer_load_dwordx4 v[156:159], v4, s[12:15], s53 offen offset:2048 sc0 sc1
    buffer_load_dwordx4 v[160:163], v4, s[12:15], s53 offen offset:3072 sc0 sc1
    buffer_load_dwordx4 v[164:167], v4, s[12:15], s54 offen offset:0 sc0 sc1
    buffer_load_dwordx4 v[168:171], v4, s[12:15], s54 offen offset:1024 sc0 sc1
    s_barrier
    v_pk_mul_f32 v[172:173], v[76:77], v[76:77]
    v_pk_mul_f32 v[174:175], v[78:79], v[78:79]
    v_pk_mul_f32 v[176:177], v[80:81], v[80:81]
    v_pk_mul_f32 v[178:179], v[82:83], v[82:83]
    v_pk_fma_f32 v[172:173], v[172:173], s[32:33], v[18:19]
    v_pk_fma_f32 v[174:175], v[174:175], s[32:33], v[18:19]
    v_pk_fma_f32 v[176:177], v[176:177], s[32:33], v[18:19]
    v_pk_fma_f32 v[178:179], v[178:179], s[32:33], v[18:19]
    v_pk_mul_f32 v[172:173], v[172:173], v[76:77]
    v_pk_mul_f32 v[174:175], v[174:175], v[78:79]
    v_pk_mul_f32 v[176:177], v[176:177], v[80:81]
    v_pk_mul_f32 v[178:179], v[178:179], v[82:83]
    v_exp_f32 v172, v172
    v_exp_f32 v173, v173
    v_exp_f32 v174, v174
    v_exp_f32 v175, v175
    v_exp_f32 v176, v176
    v_exp_f32 v177, v177
    v_exp_f32 v178, v178
    v_exp_f32 v179, v179
    v_pk_add_f32 v[172:173], v[172:173], 1.0 op_sel_hi:[1,0]
    v_pk_add_f32 v[174:175], v[174:175], 1.0 op_sel_hi:[1,0]
    v_pk_add_f32 v[176:177], v[176:177], 1.0 op_sel_hi:[1,0]
    v_pk_add_f32 v[178:179], v[178:179], 1.0 op_sel_hi:[1,0]
    v_rcp_f32 v172, v172
    v_rcp_f32 v173, v173
    v_rcp_f32 v174, v174
    v_rcp_f32 v175, v175
    v_rcp_f32 v176, v176
    v_rcp_f32 v177, v177
    v_rcp_f32 v178, v178
    v_rcp_f32 v179, v179
    v_pk_mul_f32 v[76:77], v[76:77], v[172:173]
    v_pk_mul_f32 v[78:79], v[78:79], v[174:175]
    v_pk_mul_f32 v[80:81], v[80:81], v[176:177]
    v_pk_mul_f32 v[82:83], v[82:83], v[178:179]
    v_pk_mul_f32 v[172:173], v[84:85], v[84:85]
    v_pk_mul_f32 v[174:175], v[86:87], v[86:87]
    v_pk_mul_f32 v[176:177], v[88:89], v[88:89]
    v_pk_mul_f32 v[178:179], v[90:91], v[90:91]
    v_pk_fma_f32 v[172:173], v[172:173], s[32:33], v[18:19]
    v_pk_fma_f32 v[174:175], v[174:175], s[32:33], v[18:19]
    v_pk_fma_f32 v[176:177], v[176:177], s[32:33], v[18:19]
    v_pk_fma_f32 v[178:179], v[178:179], s[32:33], v[18:19]
    v_pk_mul_f32 v[172:173], v[172:173], v[84:85]
    v_pk_mul_f32 v[174:175], v[174:175], v[86:87]
    v_pk_mul_f32 v[176:177], v[176:177], v[88:89]
    v_pk_mul_f32 v[178:179], v[178:179], v[90:91]
    v_exp_f32 v172, v172
    v_exp_f32 v173, v173
    v_exp_f32 v174, v174
    v_exp_f32 v175, v175
    v_exp_f32 v176, v176
    v_exp_f32 v177, v177
    v_exp_f32 v178, v178
    v_exp_f32 v179, v179
    v_pk_add_f32 v[172:173], v[172:173], 1.0 op_sel_hi:[1,0]
    v_pk_add_f32 v[174:175], v[174:175], 1.0 op_sel_hi:[1,0]
    v_pk_add_f32 v[176:177], v[176:177], 1.0 op_sel_hi:[1,0]
    v_pk_add_f32 v[178:179], v[178:179], 1.0 op_sel_hi:[1,0]
    v_rcp_f32 v172, v172
    v_rcp_f32 v173, v173
    v_rcp_f32 v174, v174
    v_rcp_f32 v175, v175
    v_rcp_f32 v176, v176
    v_rcp_f32 v177, v177
    v_rcp_f32 v178, v178
    v_rcp_f32 v179, v179
    v_pk_mul_f32 v[84:85], v[84:85], v[172:173]
    v_pk_mul_f32 v[86:87], v[86:87], v[174:175]
    v_pk_mul_f32 v[88:89], v[88:89], v[176:177]
    v_pk_mul_f32 v[90:91], v[90:91], v[178:179]
    v_pk_mul_f32 v[172:173], v[92:93], v[92:93]
    v_pk_mul_f32 v[174:175], v[94:95], v[94:95]
    v_pk_mul_f32 v[176:177], v[96:97], v[96:97]
    v_pk_mul_f32 v[178:179], v[98:99], v[98:99]
    v_pk_fma_f32 v[172:173], v[172:173], s[32:33], v[18:19]
    v_pk_fma_f32 v[174:175], v[174:175], s[32:33], v[18:19]
    v_pk_fma_f32 v[176:177], v[176:177], s[32:33], v[18:19]
    v_pk_fma_f32 v[178:179], v[178:179], s[32:33], v[18:19]
    v_pk_mul_f32 v[172:173], v[172:173], v[92:93]
    v_pk_mul_f32 v[174:175], v[174:175], v[94:95]
    v_pk_mul_f32 v[176:177], v[176:177], v[96:97]
    v_pk_mul_f32 v[178:179], v[178:179], v[98:99]
    v_exp_f32 v172, v172
    v_exp_f32 v173, v173
    v_exp_f32 v174, v174
    v_exp_f32 v175, v175
    v_exp_f32 v176, v176
    v_exp_f32 v177, v177
    v_exp_f32 v178, v178
    v_exp_f32 v179, v179
    v_pk_add_f32 v[172:173], v[172:173], 1.0 op_sel_hi:[1,0]
    v_pk_add_f32 v[174:175], v[174:175], 1.0 op_sel_hi:[1,0]
    v_pk_add_f32 v[176:177], v[176:177], 1.0 op_sel_hi:[1,0]
    v_pk_add_f32 v[178:179], v[178:179], 1.0 op_sel_hi:[1,0]
    v_rcp_f32 v172, v172
    v_rcp_f32 v173, v173
    v_rcp_f32 v174, v174
    v_rcp_f32 v175, v175
    v_rcp_f32 v176, v176
    v_rcp_f32 v177, v177
    v_rcp_f32 v178, v178
    v_rcp_f32 v179, v179
    v_pk_mul_f32 v[92:93], v[92:93], v[172:173]
    v_pk_mul_f32 v[94:95], v[94:95], v[174:175]
    v_pk_mul_f32 v[96:97], v[96:97], v[176:177]
    v_pk_mul_f32 v[98:99], v[98:99], v[178:179]
    v_pk_mul_f32 v[172:173], v[100:101], v[100:101]
    v_pk_mul_f32 v[174:175], v[102:103], v[102:103]
    v_pk_mul_f32 v[176:177], v[104:105], v[104:105]
    v_pk_mul_f32 v[178:179], v[106:107], v[106:107]
    v_pk_fma_f32 v[172:173], v[172:173], s[32:33], v[18:19]
    v_pk_fma_f32 v[174:175], v[174:175], s[32:33], v[18:19]
    v_pk_fma_f32 v[176:177], v[176:177], s[32:33], v[18:19]
    v_pk_fma_f32 v[178:179], v[178:179], s[32:33], v[18:19]
    v_pk_mul_f32 v[172:173], v[172:173], v[100:101]
    v_pk_mul_f32 v[174:175], v[174:175], v[102:103]
    v_pk_mul_f32 v[176:177], v[176:177], v[104:105]
    v_pk_mul_f32 v[178:179], v[178:179], v[106:107]
    v_exp_f32 v172, v172
    v_exp_f32 v173, v173
    v_exp_f32 v174, v174
    v_exp_f32 v175, v175
    v_exp_f32 v176, v176
    v_exp_f32 v177, v177
    v_exp_f32 v178, v178
    v_exp_f32 v179, v179
    v_pk_add_f32 v[172:173], v[172:173], 1.0 op_sel_hi:[1,0]
    v_pk_add_f32 v[174:175], v[174:175], 1.0 op_sel_hi:[1,0]
    v_pk_add_f32 v[176:177], v[176:177], 1.0 op_sel_hi:[1,0]
    v_pk_add_f32 v[178:179], v[178:179], 1.0 op_sel_hi:[1,0]
    v_rcp_f32 v172, v172
    v_rcp_f32 v173, v173
    v_rcp_f32 v174, v174
    v_rcp_f32 v175, v175
    v_rcp_f32 v176, v176
    v_rcp_f32 v177, v177
    v_rcp_f32 v178, v178
    v_rcp_f32 v179, v179
    v_pk_mul_f32 v[100:101], v[100:101], v[172:173]
    v_pk_mul_f32 v[102:103], v[102:103], v[174:175]
    v_pk_mul_f32 v[104:105], v[104:105], v[176:177]
    v_pk_mul_f32 v[106:107], v[106:107], v[178:179]
    v_pk_mul_f32 v[172:173], v[108:109], v[108:109]
    v_pk_mul_f32 v[174:175], v[110:111], v[110:111]
    v_pk_mul_f32 v[176:177], v[112:113], v[112:113]
    v_pk_mul_f32 v[178:179], v[114:115], v[114:115]
    v_pk_fma_f32 v[172:173], v[172:173], s[32:33], v[18:19]
    v_pk_fma_f32 v[174:175], v[174:175], s[32:33], v[18:19]
    v_pk_fma_f32 v[176:177], v[176:177], s[32:33], v[18:19]
    v_pk_fma_f32 v[178:179], v[178:179], s[32:33], v[18:19]
    v_pk_mul_f32 v[172:173], v[172:173], v[108:109]
    v_pk_mul_f32 v[174:175], v[174:175], v[110:111]
    v_pk_mul_f32 v[176:177], v[176:177], v[112:113]
    v_pk_mul_f32 v[178:179], v[178:179], v[114:115]
    v_exp_f32 v172, v172
    v_exp_f32 v173, v173
    v_exp_f32 v174, v174
    v_exp_f32 v175, v175
    v_exp_f32 v176, v176
    v_exp_f32 v177, v177
    v_exp_f32 v178, v178
    v_exp_f32 v179, v179
    v_pk_add_f32 v[172:173], v[172:173], 1.0 op_sel_hi:[1,0]
    v_pk_add_f32 v[174:175], v[174:175], 1.0 op_sel_hi:[1,0]
    v_pk_add_f32 v[176:177], v[176:177], 1.0 op_sel_hi:[1,0]
    v_pk_add_f32 v[178:179], v[178:179], 1.0 op_sel_hi:[1,0]
    v_rcp_f32 v172, v172
    v_rcp_f32 v173, v173
    v_rcp_f32 v174, v174
    v_rcp_f32 v175, v175
    v_rcp_f32 v176, v176
    v_rcp_f32 v177, v177
    v_rcp_f32 v178, v178
    v_rcp_f32 v179, v179
    v_pk_mul_f32 v[108:109], v[108:109], v[172:173]
    v_pk_mul_f32 v[110:111], v[110:111], v[174:175]
    v_pk_mul_f32 v[112:113], v[112:113], v[176:177]
    v_pk_mul_f32 v[114:115], v[114:115], v[178:179]
    v_pk_mul_f32 v[172:173], v[116:117], v[116:117]
    v_pk_mul_f32 v[174:175], v[118:119], v[118:119]
    v_pk_mul_f32 v[176:177], v[120:121], v[120:121]
    v_pk_mul_f32 v[178:179], v[122:123], v[122:123]
    v_pk_fma_f32 v[172:173], v[172:173], s[32:33], v[18:19]
    v_pk_fma_f32 v[174:175], v[174:175], s[32:33], v[18:19]
    v_pk_fma_f32 v[176:177], v[176:177], s[32:33], v[18:19]
    v_pk_fma_f32 v[178:179], v[178:179], s[32:33], v[18:19]
    v_pk_mul_f32 v[172:173], v[172:173], v[116:117]
    v_pk_mul_f32 v[174:175], v[174:175], v[118:119]
    v_pk_mul_f32 v[176:177], v[176:177], v[120:121]
    v_pk_mul_f32 v[178:179], v[178:179], v[122:123]
    v_exp_f32 v172, v172
    v_exp_f32 v173, v173
    v_exp_f32 v174, v174
    v_exp_f32 v175, v175
    v_exp_f32 v176, v176
    v_exp_f32 v177, v177
    v_exp_f32 v178, v178
    v_exp_f32 v179, v179
    v_pk_add_f32 v[172:173], v[172:173], 1.0 op_sel_hi:[1,0]
    v_pk_add_f32 v[174:175], v[174:175], 1.0 op_sel_hi:[1,0]
    v_pk_add_f32 v[176:177], v[176:177], 1.0 op_sel_hi:[1,0]
    v_pk_add_f32 v[178:179], v[178:179], 1.0 op_sel_hi:[1,0]
    v_rcp_f32 v172, v172
    v_rcp_f32 v173, v173
    v_rcp_f32 v174, v174
    v_rcp_f32 v175, v175
    v_rcp_f32 v176, v176
    v_rcp_f32 v177, v177
    v_rcp_f32 v178, v178
    v_rcp_f32 v179, v179
    v_pk_mul_f32 v[116:117], v[116:117], v[172:173]
    v_pk_mul_f32 v[118:119], v[118:119], v[174:175]
    v_pk_mul_f32 v[120:121], v[120:121], v[176:177]
    v_pk_mul_f32 v[122:123], v[122:123], v[178:179]
    v_pk_mul_f32 v[172:173], v[124:125], v[124:125]
    v_pk_mul_f32 v[174:175], v[126:127], v[126:127]
    v_pk_mul_f32 v[176:177], v[128:129], v[128:129]
    v_pk_mul_f32 v[178:179], v[130:131], v[130:131]
    v_pk_fma_f32 v[172:173], v[172:173], s[32:33], v[18:19]
    v_pk_fma_f32 v[174:175], v[174:175], s[32:33], v[18:19]
    v_pk_fma_f32 v[176:177], v[176:177], s[32:33], v[18:19]
    v_pk_fma_f32 v[178:179], v[178:179], s[32:33], v[18:19]
    v_pk_mul_f32 v[172:173], v[172:173], v[124:125]
    v_pk_mul_f32 v[174:175], v[174:175], v[126:127]
    v_pk_mul_f32 v[176:177], v[176:177], v[128:129]
    v_pk_mul_f32 v[178:179], v[178:179], v[130:131]
    v_exp_f32 v172, v172
    v_exp_f32 v173, v173
    v_exp_f32 v174, v174
    v_exp_f32 v175, v175
    v_exp_f32 v176, v176
    v_exp_f32 v177, v177
    v_exp_f32 v178, v178
    v_exp_f32 v179, v179
    v_pk_add_f32 v[172:173], v[172:173], 1.0 op_sel_hi:[1,0]
    v_pk_add_f32 v[174:175], v[174:175], 1.0 op_sel_hi:[1,0]
    v_pk_add_f32 v[176:177], v[176:177], 1.0 op_sel_hi:[1,0]
    v_pk_add_f32 v[178:179], v[178:179], 1.0 op_sel_hi:[1,0]
    v_rcp_f32 v172, v172
    v_rcp_f32 v173, v173
    v_rcp_f32 v174, v174
    v_rcp_f32 v175, v175
    v_rcp_f32 v176, v176
    v_rcp_f32 v177, v177
    v_rcp_f32 v178, v178
    v_rcp_f32 v179, v179
    v_pk_mul_f32 v[124:125], v[124:125], v[172:173]
    v_pk_mul_f32 v[126:127], v[126:127], v[174:175]
    v_pk_mul_f32 v[128:129], v[128:129], v[176:177]
    v_pk_mul_f32 v[130:131], v[130:131], v[178:179]
    s_mov_b32 s47, 0
    s_branch tc_72c
tc_72r:
    s_sleep 1
    buffer_load_dwordx4 v[132:135], v4, s[12:15], s52 offen offset:0 sc0 sc1
    buffer_load_dwordx4 v[136:139], v4, s[12:15], s52 offen offset:1024 sc0 sc1
    buffer_load_dwordx4 v[140:143], v4, s[12:15], s52 offen offset:2048 sc0 sc1
    buffer_load_dwordx4 v[144:147], v4, s[12:15], s52 offen offset:3072 sc0 sc1
    buffer_load_dwordx4 v[148:151], v4, s[12:15], s53 offen offset:0 sc0 sc1
    buffer_load_dwordx4 v[152:155], v4, s[12:15], s53 offen offset:1024 sc0 sc1
    buffer_load_dwordx4 v[156:159], v4, s[12:15], s53 offen offset:2048 sc0 sc1
    buffer_load_dwordx4 v[160:163], v4, s[12:15], s53 offen offset:3072 sc0 sc1
    buffer_load_dwordx4 v[164:167], v4, s[12:15], s54 offen offset:0 sc0 sc1
    buffer_load_dwordx4 v[168:171], v4, s[12:15], s54 offen offset:1024 sc0 sc1
tc_72c:
    s_waitcnt vmcnt(0)
    v_xor_b32 v135, s62, v135
    v_xor_b32 v139, s62, v139
    v_xor_b32 v143, s62, v143
    v_xor_b32 v147, s62, v147
    v_xor_b32 v151, s62, v151
    v_xor_b32 v155, s62, v155
    v_xor_b32 v159, s62, v159
    v_xor_b32 v163, s62, v163
    v_xor_b32 v167, s62, v167
    v_xor_b32 v171, s62, v171
    v_or_b32 v7, v135, v139
    v_or3_b32 v7, v7, v143, v147
    v_or3_b32 v7, v7, v151, v155
    v_or3_b32 v7, v7, v159, v163
    v_or3_b32 v7, v7, v167, v171
    v_cmp_ne_u32 vcc, 0, v7
    s_add_u32 s47, s47, 1
    s_cmp_gt_u32 s47, 0x40000
    s_cbranch_scc1 tc_72x
    s_cbranch_vccnz tc_72r
tc_72x:
    v_mov_b32 v172, v134
    v_mov_b32 v173, v138
    v_mov_b32 v174, v142
    v_mov_b32 v175, v146
    v_mov_b32 v176, v150
    v_mov_b32 v177, v154
    v_mov_b32 v178, v158
    v_mov_b32 v179, v162
    v_mfma_f32_16x16x16_bf16 v[20:23], v[246:247], v[132:133], v[20:23]
    v_mfma_f32_16x16x16_bf16 v[24:27], v[246:247], v[136:137], v[24:27]
    v_mfma_f32_16x16x16_bf16 v[28:31], v[246:247], v[140:141], v[28:31]
    v_mfma_f32_16x16x16_bf16 v[32:35], v[246:247], v[144:145], v[32:35]
    v_mfma_f32_16x16x16_bf16 v[36:39], v[246:247], v[148:149], v[36:39]
    v_mfma_f32_16x16x16_bf16 v[40:43], v[246:247], v[152:153], v[40:43]
    s_nop 2
    v_pk_mul_f32 v[20:21], v[20:21], v[76:77]
    v_pk_mul_f32 v[22:23], v[22:23], v[78:79]
    v_pk_mul_f32 v[24:25], v[24:25], v[80:81]
    v_pk_mul_f32 v[26:27], v[26:27], v[82:83]
    v_mfma_f32_16x16x16_bf16 v[48:51], v[246:247], v[160:161], v[48:51]
    v_cvt_pk_bf16_f32 v204, v20, v21
    v_cvt_pk_bf16_f32 v205, v22, v23
    v_cvt_pk_bf16_f32 v206, v24, v25
    v_cvt_pk_bf16_f32 v207, v26, v27
    v_mfma_f32_16x16x16_bf16 v[52:55], v[246:247], v[164:165], v[52:55]
    buffer_store_dwordx4 v[204:207], v4, s[12:15], s34 offen offset:0 sc0 sc1
    v_pk_mul_f32 v[28:29], v[28:29], v[84:85]
    v_pk_mul_f32 v[30:31], v[30:31], v[86:87]
    v_pk_mul_f32 v[32:33], v[32:33], v[88:89]
    v_pk_mul_f32 v[34:35], v[34:35], v[90:91]
    v_mfma_f32_16x16x16_bf16 v[56:59], v[246:247], v[168:169], v[56:59]
    v_cvt_pk_bf16_f32 v208, v28, v29
    v_cvt_pk_bf16_f32 v209, v30, v31
    v_cvt_pk_bf16_f32 v210, v32, v33
    v_cvt_pk_bf16_f32 v211, v34, v35
    v_mfma_f32_16x16x16_bf16 v[60:63], v[246:247], v[172:173], v[60:63]
    buffer_store_dwordx4 v[208:211], v4, s[12:15], s34 offen offset:1024 sc0 sc1
    v_pk_mul_f32 v[36:37], v[36:37], v[92:93]
    v_pk_mul_f32 v[38:39], v[38:39], v[94:95]
    v_pk_mul_f32 v[40:41], v[40:41], v[96:97]
    v_pk_mul_f32 v[42:43], v[42:43], v[98:99]
    v_mfma_f32_16x16x16_bf16 v[64:67], v[246:247], v[174:175], v[64:67]
    v_cvt_pk_bf16_f32 v212, v36, v37
    v_cvt_pk_bf16_f32 v213, v38, v39
    v_cvt_pk_bf16_f32 v214, v40, v41
    v_cvt_pk_bf16_f32 v215, v42, v43
    v_mfma_f32_16x16x16_bf16 v[68:71], v[246:247], v[176:177], v[68:71]
    buffer_store_dwordx4 v[212:215], v4, s[12:15], s34 offen offset:2048 sc0 sc1
    v_pk_mul_f32 v[48:49], v[48:49], v[104:105]
    v_pk_mul_f32 v[50:51], v[50:51], v[106:107]
    v_pk_mul_f32 v[52:53], v[52:53], v[108:109]
    v_pk_mul_f32 v[54:55], v[54:55], v[110:111]
    v_mfma_f32_16x16x16_bf16 v[44:47], v[246:247], v[156:157], v[44:47]
    v_cvt_pk_bf16_f32 v216, v48, v49
    v_cvt_pk_bf16_f32 v217, v50, v51
    v_cvt_pk_bf16_f32 v218, v52, v53
    v_cvt_pk_bf16_f32 v219, v54, v55
    v_mfma_f32_16x16x16_bf16 v[72:75], v[246:247], v[178:179], v[72:75]
    buffer_store_dwordx4 v[216:219], v4, s[12:15], s34 offen offset:3072 sc0 sc1
    v_pk_mul_f32 v[56:57], v[56:57], v[112:113]
    v_pk_mul_f32 v[58:59], v[58:59], v[114:115]
    v_pk_mul_f32 v[60:61], v[60:61], v[116:117]
    v_pk_mul_f32 v[62:63], v[62:63], v[118:119]
    v_cvt_pk_bf16_f32 v220, v56, v57
    v_cvt_pk_bf16_f32 v221, v58, v59
    v_cvt_pk_bf16_f32 v222, v60, v61
    v_cvt_pk_bf16_f32 v223, v62, v63
    buffer_store_dwordx4 v[220:223], v4, s[12:15], s35 offen offset:0 sc0 sc1
    v_pk_mul_f32 v[64:65], v[64:65], v[120:121]
    v_pk_mul_f32 v[66:67], v[66:67], v[122:123]
    v_pk_mul_f32 v[68:69], v[68:69], v[124:125]
    v_pk_mul_f32 v[70:71], v[70:71], v[126:127]
    v_cvt_pk_bf16_f32 v224, v64, v65
    v_cvt_pk_bf16_f32 v225, v66, v67
    v_cvt_pk_bf16_f32 v226, v68, v69
    v_cvt_pk_bf16_f32 v227, v70, v71
    buffer_store_dwordx4 v[224:227], v4, s[12:15], s35 offen offset:1024 sc0 sc1
    v_pk_mul_f32 v[44:45], v[44:45], v[100:101]
    v_pk_mul_f32 v[46:47], v[46:47], v[102:103]
    v_pk_mul_f32 v[72:73], v[72:73], v[128:129]
    v_pk_mul_f32 v[74:75], v[74:75], v[130:131]
    v_cvt_pk_bf16_f32 v228, v44, v45
    v_cvt_pk_bf16_f32 v229, v46, v47
    v_cvt_pk_bf16_f32 v230, v72, v73
    v_cvt_pk_bf16_f32 v231, v74, v75
    buffer_store_dwordx4 v[228:231], v4, s[12:15], s35 offen offset:2048 sc0 sc1
f_e2:
    s_waitcnt lgkmcnt(0)
    s_barrier
    s_mov_b32 s4, s82
    s_and_b32 s5, s83, 0xffff
    s_mov_b32 s6, 0x00200000
    s_mov_b32 s7, 0x20000
    s_and_b32 s28, s29, 1
    s_lshr_b32 s29, s29, 1
    s_lshl_b32 s33, s44, 2
    s_lshl_b32 s24, s28, 1
    s_add_u32 s33, s33, s24
    s_lshl_b32 s24, s28, 12
    v_add_u32 v12, s24, v4
    v_add_u32 v13, 8, v12
    s_lshl_b32 s25, s29, 1
    v_mov_b32 v244, s62
    v_mov_b32 v245, s63
    v_lshrrev_b32 v7, 2, v2
    v_lshl_add_u32 v18, v3, 2, v7
    v_lshlrev_b32 v18, 7, v18
    v_and_b32 v19, 3, v2
    v_lshl_add_u32 v18, v19, 3, v18
    v_add_u32 v18, 0, v18
    v_lshrrev_b32 v7, 3, v2
    v_and_b32 v19, 1, v3
    v_lshl_or_b32 v7, v19, 1, v7
    v_xor_b32 v7, s25, v7
    v_lshl_add_u32 v8, v7, 5, v18
    v_xor_b32 v9, 32, v8
    v_add_u32 v14, 65536, v8
    v_add_u32 v15, 65536, v9
    v_add_u32 v16, 131072, v8
    v_add_u32 v17, 131072, v9
    v_pk_mov_b32 v[44:45], 0, 0
    v_pk_mov_b32 v[46:47], 0, 0
    v_pk_mov_b32 v[48:49], 0, 0
    v_pk_mov_b32 v[50:51], 0, 0
    v_pk_mov_b32 v[52:53], 0, 0
    v_pk_mov_b32 v[54:55], 0, 0
    v_pk_mov_b32 v[56:57], 0, 0
    v_pk_mov_b32 v[58:59], 0, 0
    s_cmp_eq_u32 s27, 0
    s_cbranch_scc0 f_nohf
    v_mov_b32 v244, s62
    v_mov_b32 v245, s63
    s_waitcnt vmcnt(0)
    s_mov_b64 exec, 1
    buffer_store_dwordx2 v[244:245], off, s[12:15], s36 sc0 sc1
    s_mov_b64 exec, -1
f_nohf:
    s_lshl_b32 s24, s33, 6
    s_add_u32 s24, s24, 294912
    v_lshlrev_b32 v7, 2, v2
    buffer_load_dword v60, v7, s[12:15], s24 offen sc1
    buffer_load_dword v62, v7, s[12:15], s24 offen offset:64 sc1
    s_lshl_b32 s38, s3, 2
    s_add_u32 s38, s38, s20
    s_mul_i32 s38, s38, 3072
    s_add_u32 s38, s38, 9961472
    s_add_u32 s39, s38, 4096
    s_cmp_eq_u32 s27, 0
    s_cbranch_scc1 f_oskip
    s_barrier
    ds_read_b64_tr_b16 v[112:113], v14 offset:0
    ds_read_b64_tr_b16 v[114:115], v14 offset:2048
    ds_read_b64_tr_b16 v[116:117], v15 offset:0
    ds_read_b64_tr_b16 v[118:119], v15 offset:2048
    ds_read_b128 v[80:83], v12 offset:0
    ds_read_b128 v[84:87], v12 offset:1024
    ds_read_b128 v[96:99], v12 offset:8192
    ds_read_b128 v[100:103], v12 offset:9216
    ds_read_b64_tr_b16 v[120:121], v14 offset:4096
    ds_read_b64_tr_b16 v[122:123], v14 offset:6144
    ds_read_b64_tr_b16 v[124:125], v15 offset:4096
    ds_read_b64_tr_b16 v[126:127], v15 offset:6144
    ds_read_b128 v[88:91], v12 offset:2048
    ds_read_b128 v[92:95], v12 offset:3072
    ds_read_b128 v[104:107], v12 offset:10240
    ds_read_b128 v[108:111], v12 offset:11264
    s_waitcnt lgkmcnt(10)
    v_swap_b32 v82, v84
    v_swap_b32 v83, v85
    s_nop 1
    v_mfma_f32_16x16x32_bf16 v[20:23], v[112:115], v[80:83], 0
    v_mfma_f32_16x16x32_bf16 v[24:27], v[116:119], v[80:83], 0
    s_waitcnt lgkmcnt(8)
    v_swap_b32 v98, v100
    v_swap_b32 v99, v101
    v_mfma_f32_16x16x32_bf16 v[28:31], v[112:115], v[84:87], 0
    s_waitcnt lgkmcnt(0)
    s_barrier
    v_mfma_f32_16x16x32_bf16 v[32:35], v[116:119], v[84:87], 0
    ds_read_b64_tr_b16 v[160:161], v14 offset:8192
    v_mfma_f32_16x16x32_bf16 v[176:179], v[112:115], v[96:99], 0
    ds_read_b64_tr_b16 v[162:163], v14 offset:10240
    ds_read_b64_tr_b16 v[164:165], v15 offset:8192
    v_mfma_f32_16x16x32_bf16 v[180:183], v[116:119], v[96:99], 0
    v_swap_b32 v90, v92
    v_swap_b32 v91, v93
    ds_read_b64_tr_b16 v[166:167], v15 offset:10240
    v_mfma_f32_16x16x32_bf16 v[184:187], v[112:115], v[100:103], 0
    ds_read_b128 v[128:131], v12 offset:16384
    v_mfma_f32_16x16x32_bf16 v[188:191], v[116:119], v[100:103], 0
    ds_read_b128 v[132:135], v12 offset:17408
    ds_read_b128 v[144:147], v12 offset:24576
    v_mfma_f32_16x16x32_bf16 v[20:23], v[120:123], v[88:91], v[20:23]
    ds_read_b128 v[148:151], v12 offset:25600
    v_mfma_f32_16x16x32_bf16 v[24:27], v[124:127], v[88:91], v[24:27]
    v_swap_b32 v106, v108
    v_swap_b32 v107, v109
    ds_read_b64_tr_b16 v[168:169], v14 offset:12288
    v_mfma_f32_16x16x32_bf16 v[28:31], v[120:123], v[92:95], v[28:31]
    ds_read_b64_tr_b16 v[170:171], v14 offset:14336
    ds_read_b64_tr_b16 v[172:173], v15 offset:12288
    v_mfma_f32_16x16x32_bf16 v[32:35], v[124:127], v[92:95], v[32:35]
    ds_read_b64_tr_b16 v[174:175], v15 offset:14336
    v_mfma_f32_16x16x32_bf16 v[176:179], v[120:123], v[104:107], v[176:179]
    ds_read_b128 v[136:139], v12 offset:18432
    v_mfma_f32_16x16x32_bf16 v[180:183], v[124:127], v[104:107], v[180:183]
    ds_read_b128 v[140:143], v12 offset:19456
    ds_read_b128 v[152:155], v12 offset:26624
    v_mfma_f32_16x16x32_bf16 v[184:187], v[120:123], v[108:111], v[184:187]
    s_waitcnt lgkmcnt(7)
    v_swap_b32 v130, v132
    v_swap_b32 v131, v133
    ds_read_b128 v[156:159], v12 offset:27648
    v_mfma_f32_16x16x32_bf16 v[188:191], v[124:127], v[108:111], v[188:191]
    v_mfma_f32_16x16x32_bf16 v[20:23], v[160:163], v[128:131], v[20:23]
    v_mfma_f32_16x16x32_bf16 v[24:27], v[164:167], v[128:131], v[24:27]
    v_swap_b32 v146, v148
    v_swap_b32 v147, v149
    v_mfma_f32_16x16x32_bf16 v[28:31], v[160:163], v[132:135], v[28:31]
    s_waitcnt lgkmcnt(0)
    s_barrier
    v_mfma_f32_16x16x32_bf16 v[32:35], v[164:167], v[132:135], v[32:35]
    ds_read_b64_tr_b16 v[112:113], v14 offset:16384
    v_mfma_f32_16x16x32_bf16 v[176:179], v[160:163], v[144:147], v[176:179]
    ds_read_b64_tr_b16 v[114:115], v14 offset:18432
    ds_read_b64_tr_b16 v[116:117], v15 offset:16384
    v_mfma_f32_16x16x32_bf16 v[180:183], v[164:167], v[144:147], v[180:183]
    v_swap_b32 v138, v140
    v_swap_b32 v139, v141
    ds_read_b64_tr_b16 v[118:119], v15 offset:18432
    v_mfma_f32_16x16x32_bf16 v[184:187], v[160:163], v[148:151], v[184:187]
    ds_read_b128 v[80:83], v12 offset:32768
    v_mfma_f32_16x16x32_bf16 v[188:191], v[164:167], v[148:151], v[188:191]
    ds_read_b128 v[84:87], v12 offset:33792
    ds_read_b128 v[96:99], v12 offset:40960
    v_mfma_f32_16x16x32_bf16 v[20:23], v[168:171], v[136:139], v[20:23]
    ds_read_b128 v[100:103], v12 offset:41984
    v_mfma_f32_16x16x32_bf16 v[24:27], v[172:175], v[136:139], v[24:27]
    v_swap_b32 v154, v156
    v_swap_b32 v155, v157
    ds_read_b64_tr_b16 v[120:121], v14 offset:20480
    v_mfma_f32_16x16x32_bf16 v[28:31], v[168:171], v[140:143], v[28:31]
    ds_read_b64_tr_b16 v[122:123], v14 offset:22528
    ds_read_b64_tr_b16 v[124:125], v15 offset:20480
    v_mfma_f32_16x16x32_bf16 v[32:35], v[172:175], v[140:143], v[32:35]
    ds_read_b64_tr_b16 v[126:127], v15 offset:22528
    v_mfma_f32_16x16x32_bf16 v[176:179], v[168:171], v[152:155], v[176:179]
    ds_read_b128 v[88:91], v12 offset:34816
    v_mfma_f32_16x16x32_bf16 v[180:183], v[172:175], v[152:155], v[180:183]
    ds_read_b128 v[92:95], v12 offset:35840
    ds_read_b128 v[104:107], v12 offset:43008
    v_mfma_f32_16x16x32_bf16 v[184:187], v[168:171], v[156:159], v[184:187]
    s_waitcnt lgkmcnt(7)
    v_swap_b32 v82, v84
    v_swap_b32 v83, v85
    ds_read_b128 v[108:111], v12 offset:44032
    v_mfma_f32_16x16x32_bf16 v[188:191], v[172:175], v[156:159], v[188:191]
    v_mfma_f32_16x16x32_bf16 v[20:23], v[112:115], v[80:83], v[20:23]
    v_mfma_f32_16x16x32_bf16 v[24:27], v[116:119], v[80:83], v[24:27]
    v_swap_b32 v98, v100
    v_swap_b32 v99, v101
    v_mfma_f32_16x16x32_bf16 v[28:31], v[112:115], v[84:87], v[28:31]
    s_waitcnt lgkmcnt(0)
    s_barrier
    v_mfma_f32_16x16x32_bf16 v[32:35], v[116:119], v[84:87], v[32:35]
    ds_read_b64_tr_b16 v[160:161], v14 offset:24576
    v_mfma_f32_16x16x32_bf16 v[176:179], v[112:115], v[96:99], v[176:179]
    ds_read_b64_tr_b16 v[162:163], v14 offset:26624
    ds_read_b64_tr_b16 v[164:165], v15 offset:24576
    v_mfma_f32_16x16x32_bf16 v[180:183], v[116:119], v[96:99], v[180:183]
    v_swap_b32 v90, v92
    v_swap_b32 v91, v93
    ds_read_b64_tr_b16 v[166:167], v15 offset:26624
    v_mfma_f32_16x16x32_bf16 v[184:187], v[112:115], v[100:103], v[184:187]
    ds_read_b128 v[128:131], v12 offset:49152
    v_mfma_f32_16x16x32_bf16 v[188:191], v[116:119], v[100:103], v[188:191]
    ds_read_b128 v[132:135], v12 offset:50176
    ds_read_b128 v[144:147], v12 offset:57344
    v_mfma_f32_16x16x32_bf16 v[20:23], v[120:123], v[88:91], v[20:23]
    ds_read_b128 v[148:151], v12 offset:58368
    v_mfma_f32_16x16x32_bf16 v[24:27], v[124:127], v[88:91], v[24:27]
    v_swap_b32 v106, v108
    v_swap_b32 v107, v109
    ds_read_b64_tr_b16 v[168:169], v14 offset:28672
    v_mfma_f32_16x16x32_bf16 v[28:31], v[120:123], v[92:95], v[28:31]
    ds_read_b64_tr_b16 v[170:171], v14 offset:30720
    ds_read_b64_tr_b16 v[172:173], v15 offset:28672
    v_mfma_f32_16x16x32_bf16 v[32:35], v[124:127], v[92:95], v[32:35]
    ds_read_b64_tr_b16 v[174:175], v15 offset:30720
    v_mfma_f32_16x16x32_bf16 v[176:179], v[120:123], v[104:107], v[176:179]
    ds_read_b128 v[136:139], v12 offset:51200
    v_mfma_f32_16x16x32_bf16 v[180:183], v[124:127], v[104:107], v[180:183]
    ds_read_b128 v[140:143], v12 offset:52224
    ds_read_b128 v[152:155], v12 offset:59392
    v_mfma_f32_16x16x32_bf16 v[184:187], v[120:123], v[108:111], v[184:187]
    s_waitcnt lgkmcnt(7)
    v_swap_b32 v130, v132
    v_swap_b32 v131, v133
    ds_read_b128 v[156:159], v12 offset:60416
    v_mfma_f32_16x16x32_bf16 v[188:191], v[124:127], v[108:111], v[188:191]
    v_mfma_f32_16x16x32_bf16 v[20:23], v[160:163], v[128:131], v[20:23]
    v_mfma_f32_16x16x32_bf16 v[24:27], v[164:167], v[128:131], v[24:27]
    v_swap_b32 v146, v148
    v_swap_b32 v147, v149
    v_mfma_f32_16x16x32_bf16 v[28:31], v[160:163], v[132:135], v[28:31]
    s_waitcnt lgkmcnt(0)
    s_barrier
    v_mfma_f32_16x16x32_bf16 v[32:35], v[164:167], v[132:135], v[32:35]
    ds_read_b64_tr_b16 v[112:113], v14 offset:32768
    v_mfma_f32_16x16x32_bf16 v[176:179], v[160:163], v[144:147], v[176:179]
    ds_read_b64_tr_b16 v[114:115], v14 offset:34816
    ds_read_b64_tr_b16 v[116:117], v15 offset:32768
    v_mfma_f32_16x16x32_bf16 v[180:183], v[164:167], v[144:147], v[180:183]
    v_swap_b32 v138, v140
    v_swap_b32 v139, v141
    ds_read_b64_tr_b16 v[118:119], v15 offset:34816
    v_mfma_f32_16x16x32_bf16 v[184:187], v[160:163], v[148:151], v[184:187]
    ds_read_b128 v[80:83], v12 offset:0
    v_mfma_f32_16x16x32_bf16 v[188:191], v[164:167], v[148:151], v[188:191]
    ds_read_b128 v[84:87], v12 offset:1024
    ds_read_b128 v[96:99], v12 offset:8192
    v_mfma_f32_16x16x32_bf16 v[20:23], v[168:171], v[136:139], v[20:23]
    ds_read_b128 v[100:103], v12 offset:9216
    v_mfma_f32_16x16x32_bf16 v[24:27], v[172:175], v[136:139], v[24:27]
    v_swap_b32 v154, v156
    v_swap_b32 v155, v157
    ds_read_b64_tr_b16 v[120:121], v14 offset:36864
    v_mfma_f32_16x16x32_bf16 v[28:31], v[168:171], v[140:143], v[28:31]
    ds_read_b64_tr_b16 v[122:123], v14 offset:38912
    ds_read_b64_tr_b16 v[124:125], v15 offset:36864
    v_mfma_f32_16x16x32_bf16 v[32:35], v[172:175], v[140:143], v[32:35]
    ds_read_b64_tr_b16 v[126:127], v15 offset:38912
    v_mfma_f32_16x16x32_bf16 v[176:179], v[168:171], v[152:155], v[176:179]
    ds_read_b128 v[88:91], v12 offset:2048
    v_mfma_f32_16x16x32_bf16 v[180:183], v[172:175], v[152:155], v[180:183]
    ds_read_b128 v[92:95], v12 offset:3072
    ds_read_b128 v[104:107], v12 offset:10240
    v_mfma_f32_16x16x32_bf16 v[184:187], v[168:171], v[156:159], v[184:187]
    s_waitcnt lgkmcnt(7)
    v_swap_b32 v82, v84
    v_swap_b32 v83, v85
    ds_read_b128 v[108:111], v12 offset:11264
    v_mfma_f32_16x16x32_bf16 v[188:191], v[172:175], v[156:159], v[188:191]
    v_mfma_f32_16x16x32_bf16 v[20:23], v[112:115], v[80:83], v[20:23]
    v_mfma_f32_16x16x32_bf16 v[24:27], v[116:119], v[80:83], v[24:27]
    v_swap_b32 v98, v100
    v_swap_b32 v99, v101
    v_mfma_f32_16x16x32_bf16 v[28:31], v[112:115], v[84:87], v[28:31]
    s_waitcnt lgkmcnt(0)
    s_barrier
    v_mfma_f32_16x16x32_bf16 v[32:35], v[116:119], v[84:87], v[32:35]
    ds_read_b64_tr_b16 v[160:161], v14 offset:40960
    v_mfma_f32_16x16x32_bf16 v[176:179], v[112:115], v[96:99], v[176:179]
    ds_read_b64_tr_b16 v[162:163], v14 offset:43008
    ds_read_b64_tr_b16 v[164:165], v15 offset:40960
    v_mfma_f32_16x16x32_bf16 v[180:183], v[116:119], v[96:99], v[180:183]
    v_swap_b32 v90, v92
    v_swap_b32 v91, v93
    ds_read_b64_tr_b16 v[166:167], v15 offset:43008
    v_mfma_f32_16x16x32_bf16 v[184:187], v[112:115], v[100:103], v[184:187]
    ds_read_b128 v[128:131], v12 offset:16384
    v_mfma_f32_16x16x32_bf16 v[188:191], v[116:119], v[100:103], v[188:191]
    ds_read_b128 v[132:135], v12 offset:17408
    ds_read_b128 v[144:147], v12 offset:24576
    v_mfma_f32_16x16x32_bf16 v[20:23], v[120:123], v[88:91], v[20:23]
    ds_read_b128 v[148:151], v12 offset:25600
    v_mfma_f32_16x16x32_bf16 v[24:27], v[124:127], v[88:91], v[24:27]
    v_swap_b32 v106, v108
    v_swap_b32 v107, v109
    ds_read_b64_tr_b16 v[168:169], v14 offset:45056
    v_mfma_f32_16x16x32_bf16 v[28:31], v[120:123], v[92:95], v[28:31]
    ds_read_b64_tr_b16 v[170:171], v14 offset:47104
    ds_read_b64_tr_b16 v[172:173], v15 offset:45056
    v_mfma_f32_16x16x32_bf16 v[32:35], v[124:127], v[92:95], v[32:35]
    ds_read_b64_tr_b16 v[174:175], v15 offset:47104
    v_mfma_f32_16x16x32_bf16 v[176:179], v[120:123], v[104:107], v[176:179]
    ds_read_b128 v[136:139], v12 offset:18432
    v_mfma_f32_16x16x32_bf16 v[180:183], v[124:127], v[104:107], v[180:183]
    ds_read_b128 v[140:143], v12 offset:19456
    ds_read_b128 v[152:155], v12 offset:26624
    v_mfma_f32_16x16x32_bf16 v[184:187], v[120:123], v[108:111], v[184:187]
    s_waitcnt lgkmcnt(7)
    v_swap_b32 v130, v132
    v_swap_b32 v131, v133
    ds_read_b128 v[156:159], v12 offset:27648
    v_mfma_f32_16x16x32_bf16 v[188:191], v[124:127], v[108:111], v[188:191]
    v_mfma_f32_16x16x32_bf16 v[20:23], v[160:163], v[128:131], v[20:23]
    v_mfma_f32_16x16x32_bf16 v[24:27], v[164:167], v[128:131], v[24:27]
    v_swap_b32 v146, v148
    v_swap_b32 v147, v149
    v_mfma_f32_16x16x32_bf16 v[28:31], v[160:163], v[132:135], v[28:31]
    s_waitcnt lgkmcnt(0)
    s_barrier
    v_mfma_f32_16x16x32_bf16 v[32:35], v[164:167], v[132:135], v[32:35]
    ds_read_b64_tr_b16 v[112:113], v14 offset:49152
    v_mfma_f32_16x16x32_bf16 v[176:179], v[160:163], v[144:147], v[176:179]
    ds_read_b64_tr_b16 v[114:115], v14 offset:51200
    ds_read_b64_tr_b16 v[116:117], v15 offset:49152
    v_mfma_f32_16x16x32_bf16 v[180:183], v[164:167], v[144:147], v[180:183]
    v_swap_b32 v138, v140
    v_swap_b32 v139, v141
    ds_read_b64_tr_b16 v[118:119], v15 offset:51200
    v_mfma_f32_16x16x32_bf16 v[184:187], v[160:163], v[148:151], v[184:187]
    ds_read_b128 v[80:83], v12 offset:32768
    v_mfma_f32_16x16x32_bf16 v[188:191], v[164:167], v[148:151], v[188:191]
    ds_read_b128 v[84:87], v12 offset:33792
    ds_read_b128 v[96:99], v12 offset:40960
    v_mfma_f32_16x16x32_bf16 v[20:23], v[168:171], v[136:139], v[20:23]
    ds_read_b128 v[100:103], v12 offset:41984
    v_mfma_f32_16x16x32_bf16 v[24:27], v[172:175], v[136:139], v[24:27]
    v_swap_b32 v154, v156
    v_swap_b32 v155, v157
    ds_read_b64_tr_b16 v[120:121], v14 offset:53248
    v_mfma_f32_16x16x32_bf16 v[28:31], v[168:171], v[140:143], v[28:31]
    ds_read_b64_tr_b16 v[122:123], v14 offset:55296
    ds_read_b64_tr_b16 v[124:125], v15 offset:53248
    v_mfma_f32_16x16x32_bf16 v[32:35], v[172:175], v[140:143], v[32:35]
    ds_read_b64_tr_b16 v[126:127], v15 offset:55296
    v_mfma_f32_16x16x32_bf16 v[176:179], v[168:171], v[152:155], v[176:179]
    ds_read_b128 v[88:91], v12 offset:34816
    v_mfma_f32_16x16x32_bf16 v[180:183], v[172:175], v[152:155], v[180:183]
    ds_read_b128 v[92:95], v12 offset:35840
    ds_read_b128 v[104:107], v12 offset:43008
    v_mfma_f32_16x16x32_bf16 v[184:187], v[168:171], v[156:159], v[184:187]
    s_waitcnt lgkmcnt(7)
    v_swap_b32 v82, v84
    v_swap_b32 v83, v85
    ds_read_b128 v[108:111], v12 offset:44032
    v_mfma_f32_16x16x32_bf16 v[188:191], v[172:175], v[156:159], v[188:191]
    v_mfma_f32_16x16x32_bf16 v[20:23], v[112:115], v[80:83], v[20:23]
    v_mfma_f32_16x16x32_bf16 v[24:27], v[116:119], v[80:83], v[24:27]
    v_swap_b32 v98, v100
    v_swap_b32 v99, v101
    v_mfma_f32_16x16x32_bf16 v[28:31], v[112:115], v[84:87], v[28:31]
    s_waitcnt lgkmcnt(0)
    s_barrier
    v_mfma_f32_16x16x32_bf16 v[32:35], v[116:119], v[84:87], v[32:35]
    ds_read_b64_tr_b16 v[160:161], v14 offset:57344
    v_mfma_f32_16x16x32_bf16 v[176:179], v[112:115], v[96:99], v[176:179]
    ds_read_b64_tr_b16 v[162:163], v14 offset:59392
    ds_read_b64_tr_b16 v[164:165], v15 offset:57344
    v_mfma_f32_16x16x32_bf16 v[180:183], v[116:119], v[96:99], v[180:183]
    v_swap_b32 v90, v92
    v_swap_b32 v91, v93
    ds_read_b64_tr_b16 v[166:167], v15 offset:59392
    v_mfma_f32_16x16x32_bf16 v[184:187], v[112:115], v[100:103], v[184:187]
    ds_read_b128 v[128:131], v12 offset:49152
    v_mfma_f32_16x16x32_bf16 v[188:191], v[116:119], v[100:103], v[188:191]
    ds_read_b128 v[132:135], v12 offset:50176
    ds_read_b128 v[144:147], v12 offset:57344
    v_mfma_f32_16x16x32_bf16 v[20:23], v[120:123], v[88:91], v[20:23]
    ds_read_b128 v[148:151], v12 offset:58368
    v_mfma_f32_16x16x32_bf16 v[24:27], v[124:127], v[88:91], v[24:27]
    v_swap_b32 v106, v108
    v_swap_b32 v107, v109
    ds_read_b64_tr_b16 v[168:169], v14 offset:61440
    v_mfma_f32_16x16x32_bf16 v[28:31], v[120:123], v[92:95], v[28:31]
    ds_read_b64_tr_b16 v[170:171], v14 offset:63488
    ds_read_b64_tr_b16 v[172:173], v15 offset:61440
    v_mfma_f32_16x16x32_bf16 v[32:35], v[124:127], v[92:95], v[32:35]
    ds_read_b64_tr_b16 v[174:175], v15 offset:63488
    v_mfma_f32_16x16x32_bf16 v[176:179], v[120:123], v[104:107], v[176:179]
    ds_read_b128 v[136:139], v12 offset:51200
    v_mfma_f32_16x16x32_bf16 v[180:183], v[124:127], v[104:107], v[180:183]
    ds_read_b128 v[140:143], v12 offset:52224
    ds_read_b128 v[152:155], v12 offset:59392
    v_mfma_f32_16x16x32_bf16 v[184:187], v[120:123], v[108:111], v[184:187]
    s_waitcnt lgkmcnt(7)
    v_swap_b32 v130, v132
    v_swap_b32 v131, v133
    ds_read_b128 v[156:159], v12 offset:60416
    v_mfma_f32_16x16x32_bf16 v[188:191], v[124:127], v[108:111], v[188:191]
    v_mfma_f32_16x16x32_bf16 v[20:23], v[160:163], v[128:131], v[20:23]
    v_mfma_f32_16x16x32_bf16 v[24:27], v[164:167], v[128:131], v[24:27]
    v_swap_b32 v146, v148
    v_swap_b32 v147, v149
    v_mfma_f32_16x16x32_bf16 v[28:31], v[160:163], v[132:135], v[28:31]
    s_waitcnt lgkmcnt(0)
    s_barrier
    v_mfma_f32_16x16x32_bf16 v[32:35], v[164:167], v[132:135], v[32:35]
    v_mfma_f32_16x16x32_bf16 v[176:179], v[160:163], v[144:147], v[176:179]
    v_mfma_f32_16x16x32_bf16 v[180:183], v[164:167], v[144:147], v[180:183]
    v_swap_b32 v138, v140
    v_swap_b32 v139, v141
    v_mfma_f32_16x16x32_bf16 v[184:187], v[160:163], v[148:151], v[184:187]
    v_mfma_f32_16x16x32_bf16 v[188:191], v[164:167], v[148:151], v[188:191]
    v_mfma_f32_16x16x32_bf16 v[20:23], v[168:171], v[136:139], v[20:23]
    v_mfma_f32_16x16x32_bf16 v[24:27], v[172:175], v[136:139], v[24:27]
    v_swap_b32 v154, v156
    v_swap_b32 v155, v157
    v_mfma_f32_16x16x32_bf16 v[28:31], v[168:171], v[140:143], v[28:31]
    v_mfma_f32_16x16x32_bf16 v[32:35], v[172:175], v[140:143], v[32:35]
    v_mfma_f32_16x16x32_bf16 v[176:179], v[168:171], v[152:155], v[176:179]
    v_mfma_f32_16x16x32_bf16 v[180:183], v[172:175], v[152:155], v[180:183]
    v_mfma_f32_16x16x32_bf16 v[184:187], v[168:171], v[156:159], v[184:187]
    v_mfma_f32_16x16x32_bf16 v[188:191], v[172:175], v[156:159], v[188:191]
    s_nop 4
    v_cvt_pk_bf16_f32 v80, v176, v177
    v_cvt_pk_bf16_f32 v81, v178, v179
    v_cvt_pk_bf16_f32 v82, v180, v181
    v_mov_b32 v83, s62
    buffer_store_dwordx4 v[80:83], v4, s[12:15], s38 offen offset:0 sc0 sc1
    v_cvt_pk_bf16_f32 v84, v182, v183
    v_cvt_pk_bf16_f32 v85, v184, v185
    v_cvt_pk_bf16_f32 v86, v186, v187
    v_mov_b32 v87, s62
    buffer_store_dwordx4 v[84:87], v4, s[12:15], s38 offen offset:1024 sc0 sc1
    v_cvt_pk_bf16_f32 v88, v188, v189
    v_cvt_pk_bf16_f32 v89, v190, v191
    v_mov_b32 v91, s62
    buffer_store_dwordx4 v[88:91], v4, s[12:15], s38 offen offset:2048 sc0 sc1
f_oskip:
    s_mul_i32 s24, s28, 7168
    v_add_u32 v12, s24, v4
    v_add_u32 v13, 0x10000, v12
    s_barrier
    ds_read_b64_tr_b16 v[128:129], v8 offset:0
    ds_read_b64_tr_b16 v[130:131], v8 offset:2048
    ds_read_b64_tr_b16 v[140:141], v9 offset:0
    ds_read_b64_tr_b16 v[142:143], v9 offset:2048
    ds_read_b64_tr_b16 v[132:133], v8 offset:4096
    ds_read_b64_tr_b16 v[134:135], v8 offset:6144
    ds_read_b64_tr_b16 v[144:145], v9 offset:4096
    ds_read_b64_tr_b16 v[146:147], v9 offset:6144
    ds_read_b64_tr_b16 v[136:137], v8 offset:8192
    ds_read_b64_tr_b16 v[138:139], v8 offset:10240
    ds_read_b64_tr_b16 v[148:149], v9 offset:8192
    ds_read_b64_tr_b16 v[150:151], v9 offset:10240
    ds_read_b64_tr_b16 v[224:225], v8 offset:12288
    ds_read_b64_tr_b16 v[228:229], v9 offset:12288
    ds_read_b64_tr_b16 v[152:153], v8 offset:16384
    ds_read_b64_tr_b16 v[154:155], v8 offset:18432
    ds_read_b64_tr_b16 v[164:165], v9 offset:16384
    ds_read_b64_tr_b16 v[166:167], v9 offset:18432
    ds_read_b64_tr_b16 v[156:157], v8 offset:20480
    ds_read_b64_tr_b16 v[158:159], v8 offset:22528
    ds_read_b64_tr_b16 v[168:169], v9 offset:20480
    ds_read_b64_tr_b16 v[170:171], v9 offset:22528
    ds_read_b64_tr_b16 v[160:161], v8 offset:24576
    ds_read_b64_tr_b16 v[162:163], v8 offset:26624
    ds_read_b64_tr_b16 v[172:173], v9 offset:24576
    ds_read_b64_tr_b16 v[174:175], v9 offset:26624
    ds_read_b64_tr_b16 v[226:227], v8 offset:28672
    ds_read_b64_tr_b16 v[230:231], v9 offset:28672
    ds_read_b64_tr_b16 v[176:177], v8 offset:32768
    ds_read_b64_tr_b16 v[178:179], v8 offset:34816
    ds_read_b64_tr_b16 v[188:189], v9 offset:32768
    ds_read_b64_tr_b16 v[190:191], v9 offset:34816
    ds_read_b64_tr_b16 v[180:181], v8 offset:36864
    ds_read_b64_tr_b16 v[182:183], v8 offset:38912
    ds_read_b64_tr_b16 v[192:193], v9 offset:36864
    ds_read_b64_tr_b16 v[194:195], v9 offset:38912
    ds_read_b64_tr_b16 v[184:185], v8 offset:40960
    ds_read_b64_tr_b16 v[186:187], v8 offset:43008
    ds_read_b64_tr_b16 v[196:197], v9 offset:40960
    ds_read_b64_tr_b16 v[198:199], v9 offset:43008
    ds_read_b64_tr_b16 v[232:233], v8 offset:45056
    ds_read_b64_tr_b16 v[236:237], v9 offset:45056
    ds_read_b64_tr_b16 v[200:201], v8 offset:49152
    ds_read_b64_tr_b16 v[202:203], v8 offset:51200
    ds_read_b64_tr_b16 v[212:213], v9 offset:49152
    ds_read_b64_tr_b16 v[214:215], v9 offset:51200
    ds_read_b64_tr_b16 v[204:205], v8 offset:53248
    ds_read_b64_tr_b16 v[206:207], v8 offset:55296
    ds_read_b64_tr_b16 v[216:217], v9 offset:53248
    ds_read_b64_tr_b16 v[218:219], v9 offset:55296
    ds_read_b64_tr_b16 v[208:209], v8 offset:57344
    ds_read_b64_tr_b16 v[210:211], v8 offset:59392
    ds_read_b64_tr_b16 v[220:221], v9 offset:57344
    ds_read_b64_tr_b16 v[222:223], v9 offset:59392
    ds_read_b64_tr_b16 v[234:235], v8 offset:61440
    ds_read_b64_tr_b16 v[238:239], v9 offset:61440
    s_lshr_b32 s40, s33, 1
    s_lshl_b32 s40, s40, 15
    s_lshl_b32 s25, s45, 7
    s_add_u32 s40, s40, s25
    s_lshl_b32 s25, s29, 6
    s_add_u32 s40, s40, s25
    v_lshlrev_b32 v7, 11, v2
    v_and_b32 v6, 1, v3
    v_lshl_add_u32 v7, v6, 5, v7
    v_lshrrev_b32 v6, 1, v3
    v_lshl_add_u32 v7, v6, 4, v7
    s_waitcnt lgkmcnt(0)
    s_barrier
    s_barrier
    ds_read_b128 v[64:67], v12 offset:0
    ds_read_b128 v[76:79], v12 offset:3072
    ds_read_b128 v[68:71], v12 offset:1024
    ds_read_b128 v[80:83], v12 offset:4096
    ds_read_b128 v[72:75], v12 offset:2048
    ds_read_b128 v[84:87], v12 offset:5120
    ds_read_b64 v[112:113], v12 offset:6144
    ds_read_b64 v[116:117], v12 offset:6152
    s_waitcnt lgkmcnt(7)
    v_mfma_f32_16x16x32_bf16 v[44:47], v[128:131], v[64:67], v[44:47]
    v_mfma_f32_16x16x32_bf16 v[48:51], v[140:143], v[64:67], v[48:51]
    s_waitcnt lgkmcnt(0)
    s_barrier
    v_mfma_f32_16x16x32_bf16 v[52:55], v[128:131], v[76:79], v[52:55]
    ds_read_b128 v[88:91], v12 offset:16384
    v_mfma_f32_16x16x32_bf16 v[56:59], v[140:143], v[76:79], v[56:59]
    ds_read_b128 v[100:103], v12 offset:19456
    v_mfma_f32_16x16x32_bf16 v[44:47], v[132:135], v[68:71], v[44:47]
    ds_read_b128 v[92:95], v12 offset:17408
    v_mfma_f32_16x16x32_bf16 v[48:51], v[144:147], v[68:71], v[48:51]
    ds_read_b128 v[104:107], v12 offset:20480
    v_mfma_f32_16x16x32_bf16 v[52:55], v[132:135], v[80:83], v[52:55]
    ds_read_b128 v[96:99], v12 offset:18432
    v_mfma_f32_16x16x32_bf16 v[56:59], v[144:147], v[80:83], v[56:59]
    ds_read_b128 v[108:111], v12 offset:21504
    v_mfma_f32_16x16x32_bf16 v[44:47], v[136:139], v[72:75], v[44:47]
    ds_read_b64 v[114:115], v12 offset:22528
    v_mfma_f32_16x16x32_bf16 v[48:51], v[148:151], v[72:75], v[48:51]
    ds_read_b64 v[118:119], v12 offset:22536
    v_mfma_f32_16x16x32_bf16 v[52:55], v[136:139], v[84:87], v[52:55]
    v_mfma_f32_16x16x32_bf16 v[56:59], v[148:151], v[84:87], v[56:59]
    s_waitcnt lgkmcnt(4)
    v_mfma_f32_16x16x32_bf16 v[44:47], v[152:155], v[88:91], v[44:47]
    ds_read_b64_tr_b16 v[128:129], v16 offset:0
    v_mfma_f32_16x16x32_bf16 v[48:51], v[164:167], v[88:91], v[48:51]
    ds_read_b64_tr_b16 v[130:131], v16 offset:2048
    s_waitcnt lgkmcnt(2)
    s_barrier
    v_mfma_f32_16x16x32_bf16 v[52:55], v[152:155], v[100:103], v[52:55]
    ds_read_b128 v[64:67], v12 offset:32768
    v_mfma_f32_16x16x32_bf16 v[56:59], v[164:167], v[100:103], v[56:59]
    ds_read_b128 v[76:79], v12 offset:35840
    ds_read_b64_tr_b16 v[140:141], v17 offset:0
    v_mfma_f32_16x16x32_bf16 v[44:47], v[156:159], v[92:95], v[44:47]
    ds_read_b128 v[68:71], v12 offset:33792
    v_mfma_f32_16x16x32_bf16 v[48:51], v[168:171], v[92:95], v[48:51]
    ds_read_b128 v[80:83], v12 offset:36864
    v_mfma_f32_16x16x32_bf16 v[52:55], v[156:159], v[104:107], v[52:55]
    ds_read_b128 v[72:75], v12 offset:34816
    v_mfma_f32_16x16x32_bf16 v[56:59], v[168:171], v[104:107], v[56:59]
    ds_read_b128 v[84:87], v12 offset:37888
    ds_read_b64_tr_b16 v[142:143], v17 offset:2048
    v_mfma_f32_16x16x32_bf16 v[44:47], v[160:163], v[96:99], v[44:47]
    ds_read_b64 v[120:121], v12 offset:38912
    v_mfma_f32_16x16x32_bf16 v[48:51], v[172:175], v[96:99], v[48:51]
    ds_read_b64 v[124:125], v12 offset:38920
    v_mfma_f32_16x16x32_bf16 v[52:55], v[160:163], v[108:111], v[52:55]
    ds_read_b64_tr_b16 v[132:133], v16 offset:4096
    v_mfma_f32_16x16x32_bf16 v[56:59], v[172:175], v[108:111], v[56:59]
    ds_read_b64_tr_b16 v[134:135], v16 offset:6144
    ds_read_b64_tr_b16 v[144:145], v17 offset:4096
    v_mfma_f32_16x16x32_bf16 v[44:47], v[224:227], v[112:115], v[44:47]
    ds_read_b64_tr_b16 v[146:147], v17 offset:6144
    v_mfma_f32_16x16x32_bf16 v[48:51], v[228:231], v[112:115], v[48:51]
    ds_read_b64_tr_b16 v[136:137], v16 offset:8192
    v_mfma_f32_16x16x32_bf16 v[52:55], v[224:227], v[116:119], v[52:55]
    ds_read_b64_tr_b16 v[138:139], v16 offset:10240
    v_mfma_f32_16x16x32_bf16 v[56:59], v[228:231], v[116:119], v[56:59]
    ds_read_b64_tr_b16 v[148:149], v17 offset:8192
    ds_read_b64_tr_b16 v[150:151], v17 offset:10240
    s_waitcnt lgkmcnt(8)
    v_mfma_f32_16x16x32_bf16 v[44:47], v[176:179], v[64:67], v[44:47]
    ds_read_b64_tr_b16 v[240:241], v16 offset:12288
    v_mfma_f32_16x16x32_bf16 v[48:51], v[188:191], v[64:67], v[48:51]
    ds_read_b64_tr_b16 v[244:245], v17 offset:12288
    s_barrier
    v_mfma_f32_16x16x32_bf16 v[52:55], v[176:179], v[76:79], v[52:55]
    ds_read_b128 v[88:91], v12 offset:49152
    v_mfma_f32_16x16x32_bf16 v[56:59], v[188:191], v[76:79], v[56:59]
    ds_read_b128 v[100:103], v12 offset:52224
    ds_read_b64_tr_b16 v[152:153], v16 offset:16384
    v_mfma_f32_16x16x32_bf16 v[44:47], v[180:183], v[68:71], v[44:47]
    ds_read_b128 v[92:95], v12 offset:50176
    v_mfma_f32_16x16x32_bf16 v[48:51], v[192:195], v[68:71], v[48:51]
    ds_read_b128 v[104:107], v12 offset:53248
    v_mfma_f32_16x16x32_bf16 v[52:55], v[180:183], v[80:83], v[52:55]
    ds_read_b128 v[96:99], v12 offset:51200
    v_mfma_f32_16x16x32_bf16 v[56:59], v[192:195], v[80:83], v[56:59]
    ds_read_b128 v[108:111], v12 offset:54272
    ds_read_b64_tr_b16 v[154:155], v16 offset:18432
    v_mfma_f32_16x16x32_bf16 v[44:47], v[184:187], v[72:75], v[44:47]
    ds_read_b64 v[122:123], v12 offset:55296
    v_mfma_f32_16x16x32_bf16 v[48:51], v[196:199], v[72:75], v[48:51]
    ds_read_b64 v[126:127], v12 offset:55304
    v_mfma_f32_16x16x32_bf16 v[52:55], v[184:187], v[84:87], v[52:55]
    ds_read_b64_tr_b16 v[164:165], v17 offset:16384
    v_mfma_f32_16x16x32_bf16 v[56:59], v[196:199], v[84:87], v[56:59]
    ds_read_b64_tr_b16 v[166:167], v17 offset:18432
    ds_read_b64_tr_b16 v[156:157], v16 offset:20480
    s_waitcnt lgkmcnt(8)
    v_mfma_f32_16x16x32_bf16 v[44:47], v[200:203], v[88:91], v[44:47]
    ds_read_b64_tr_b16 v[158:159], v16 offset:22528
    v_mfma_f32_16x16x32_bf16 v[48:51], v[212:215], v[88:91], v[48:51]
    ds_read_b64_tr_b16 v[168:169], v17 offset:20480
    s_waitcnt lgkmcnt(5)
    s_barrier
    v_mfma_f32_16x16x32_bf16 v[52:55], v[200:203], v[100:103], v[52:55]
    ds_read_b128 v[64:67], v12 offset:0
    v_mfma_f32_16x16x32_bf16 v[56:59], v[212:215], v[100:103], v[56:59]
    ds_read_b128 v[76:79], v12 offset:3072
    ds_read_b64_tr_b16 v[170:171], v17 offset:22528
    v_mfma_f32_16x16x32_bf16 v[44:47], v[204:207], v[92:95], v[44:47]
    ds_read_b128 v[68:71], v12 offset:1024
    v_mfma_f32_16x16x32_bf16 v[48:51], v[216:219], v[92:95], v[48:51]
    ds_read_b128 v[80:83], v12 offset:4096
    v_mfma_f32_16x16x32_bf16 v[52:55], v[204:207], v[104:107], v[52:55]
    ds_read_b128 v[72:75], v12 offset:2048
    v_mfma_f32_16x16x32_bf16 v[56:59], v[216:219], v[104:107], v[56:59]
    ds_read_b128 v[84:87], v12 offset:5120
    ds_read_b64_tr_b16 v[160:161], v16 offset:24576
    v_mfma_f32_16x16x32_bf16 v[44:47], v[208:211], v[96:99], v[44:47]
    ds_read_b64 v[112:113], v12 offset:6144
    v_mfma_f32_16x16x32_bf16 v[48:51], v[220:223], v[96:99], v[48:51]
    ds_read_b64 v[116:117], v12 offset:6152
    v_mfma_f32_16x16x32_bf16 v[52:55], v[208:211], v[108:111], v[52:55]
    ds_read_b64_tr_b16 v[162:163], v16 offset:26624
    v_mfma_f32_16x16x32_bf16 v[56:59], v[220:223], v[108:111], v[56:59]
    ds_read_b64_tr_b16 v[172:173], v17 offset:24576
    ds_read_b64_tr_b16 v[174:175], v17 offset:26624
    v_mfma_f32_16x16x32_bf16 v[44:47], v[232:235], v[120:123], v[44:47]
    ds_read_b64_tr_b16 v[242:243], v16 offset:28672
    v_mfma_f32_16x16x32_bf16 v[48:51], v[236:239], v[120:123], v[48:51]
    ds_read_b64_tr_b16 v[246:247], v17 offset:28672
    v_mfma_f32_16x16x32_bf16 v[52:55], v[232:235], v[124:127], v[52:55]
    ds_read_b64_tr_b16 v[176:177], v14 offset:0
    v_mfma_f32_16x16x32_bf16 v[56:59], v[236:239], v[124:127], v[56:59]
    ds_read_b64_tr_b16 v[178:179], v14 offset:2048
    ds_read_b64_tr_b16 v[188:189], v15 offset:0
    s_cmp_eq_u32 s27, 0
    s_cbranch_scc1 f_abl
f_ablr:
    s_waitcnt lgkmcnt(8)
    v_mfma_f32_16x16x32_bf16 v[44:47], v[128:131], v[64:67], v[44:47]
    ds_read_b64_tr_b16 v[190:191], v15 offset:2048
    v_mfma_f32_16x16x32_bf16 v[48:51], v[140:143], v[64:67], v[48:51]
    ds_read_b64_tr_b16 v[180:181], v14 offset:4096
    s_barrier
    v_mfma_f32_16x16x32_bf16 v[52:55], v[128:131], v[76:79], v[52:55]
    ds_read_b128 v[88:91], v12 offset:16384
    v_mfma_f32_16x16x32_bf16 v[56:59], v[140:143], v[76:79], v[56:59]
    ds_read_b128 v[100:103], v12 offset:19456
    ds_read_b64_tr_b16 v[182:183], v14 offset:6144
    v_mfma_f32_16x16x32_bf16 v[44:47], v[132:135], v[68:71], v[44:47]
    ds_read_b128 v[92:95], v12 offset:17408
    v_mfma_f32_16x16x32_bf16 v[48:51], v[144:147], v[68:71], v[48:51]
    ds_read_b128 v[104:107], v12 offset:20480
    v_mfma_f32_16x16x32_bf16 v[52:55], v[132:135], v[80:83], v[52:55]
    ds_read_b128 v[96:99], v12 offset:18432
    v_mfma_f32_16x16x32_bf16 v[56:59], v[144:147], v[80:83], v[56:59]
    ds_read_b128 v[108:111], v12 offset:21504
    ds_read_b64_tr_b16 v[192:193], v15 offset:4096
    v_mfma_f32_16x16x32_bf16 v[44:47], v[136:139], v[72:75], v[44:47]
    ds_read_b64 v[114:115], v12 offset:22528
    v_mfma_f32_16x16x32_bf16 v[48:51], v[148:151], v[72:75], v[48:51]
    ds_read_b64 v[118:119], v12 offset:22536
    v_mfma_f32_16x16x32_bf16 v[52:55], v[136:139], v[84:87], v[52:55]
    ds_read_b64_tr_b16 v[194:195], v15 offset:6144
    v_mfma_f32_16x16x32_bf16 v[56:59], v[148:151], v[84:87], v[56:59]
    ds_read_b64_tr_b16 v[184:185], v14 offset:8192
    ds_read_b64_tr_b16 v[186:187], v14 offset:10240
    s_waitcnt lgkmcnt(8)
    v_mfma_f32_16x16x32_bf16 v[44:47], v[152:155], v[88:91], v[44:47]
    ds_read_b64_tr_b16 v[196:197], v15 offset:8192
    v_mfma_f32_16x16x32_bf16 v[48:51], v[164:167], v[88:91], v[48:51]
    ds_read_b64_tr_b16 v[198:199], v15 offset:10240
    s_waitcnt lgkmcnt(5)
    s_barrier
    v_mfma_f32_16x16x32_bf16 v[52:55], v[152:155], v[100:103], v[52:55]
    ds_read_b128 v[64:67], v12 offset:32768
    v_mfma_f32_16x16x32_bf16 v[56:59], v[164:167], v[100:103], v[56:59]
    ds_read_b128 v[76:79], v12 offset:35840
    ds_read_b64_tr_b16 v[224:225], v14 offset:12288
    v_mfma_f32_16x16x32_bf16 v[44:47], v[156:159], v[92:95], v[44:47]
    ds_read_b128 v[68:71], v12 offset:33792
    v_mfma_f32_16x16x32_bf16 v[48:51], v[168:171], v[92:95], v[48:51]
    ds_read_b128 v[80:83], v12 offset:36864
    v_mfma_f32_16x16x32_bf16 v[52:55], v[156:159], v[104:107], v[52:55]
    ds_read_b128 v[72:75], v12 offset:34816
    v_mfma_f32_16x16x32_bf16 v[56:59], v[168:171], v[104:107], v[56:59]
    ds_read_b128 v[84:87], v12 offset:37888
    ds_read_b64_tr_b16 v[228:229], v15 offset:12288
    v_mfma_f32_16x16x32_bf16 v[44:47], v[160:163], v[96:99], v[44:47]
    ds_read_b64 v[120:121], v12 offset:38912
    v_mfma_f32_16x16x32_bf16 v[48:51], v[172:175], v[96:99], v[48:51]
    ds_read_b64 v[124:125], v12 offset:38920
    v_mfma_f32_16x16x32_bf16 v[52:55], v[160:163], v[108:111], v[52:55]
    ds_read_b64_tr_b16 v[200:201], v14 offset:16384
    v_mfma_f32_16x16x32_bf16 v[56:59], v[172:175], v[108:111], v[56:59]
    ds_read_b64_tr_b16 v[202:203], v14 offset:18432
    ds_read_b64_tr_b16 v[212:213], v15 offset:16384
    v_mfma_f32_16x16x32_bf16 v[44:47], v[240:243], v[112:115], v[44:47]
    ds_read_b64_tr_b16 v[214:215], v15 offset:18432
    v_mfma_f32_16x16x32_bf16 v[48:51], v[244:247], v[112:115], v[48:51]
    ds_read_b64_tr_b16 v[204:205], v14 offset:20480
    v_mfma_f32_16x16x32_bf16 v[52:55], v[240:243], v[116:119], v[52:55]
    ds_read_b64_tr_b16 v[206:207], v14 offset:22528
    v_mfma_f32_16x16x32_bf16 v[56:59], v[244:247], v[116:119], v[56:59]
    ds_read_b64_tr_b16 v[216:217], v15 offset:20480
    ds_read_b64_tr_b16 v[218:219], v15 offset:22528
    s_waitcnt lgkmcnt(8)
    v_mfma_f32_16x16x32_bf16 v[44:47], v[176:179], v[64:67], v[44:47]
    ds_read_b64_tr_b16 v[208:209], v14 offset:24576
    v_mfma_f32_16x16x32_bf16 v[48:51], v[188:191], v[64:67], v[48:51]
    ds_read_b64_tr_b16 v[210:211], v14 offset:26624
    s_barrier
    v_mfma_f32_16x16x32_bf16 v[52:55], v[176:179], v[76:79], v[52:55]
    ds_read_b128 v[88:91], v12 offset:49152
    v_mfma_f32_16x16x32_bf16 v[56:59], v[188:191], v[76:79], v[56:59]
    ds_read_b128 v[100:103], v12 offset:52224
    ds_read_b64_tr_b16 v[220:221], v15 offset:24576
    v_mfma_f32_16x16x32_bf16 v[44:47], v[180:183], v[68:71], v[44:47]
    ds_read_b128 v[92:95], v12 offset:50176
    v_mfma_f32_16x16x32_bf16 v[48:51], v[192:195], v[68:71], v[48:51]
    ds_read_b128 v[104:107], v12 offset:53248
    v_mfma_f32_16x16x32_bf16 v[52:55], v[180:183], v[80:83], v[52:55]
    ds_read_b128 v[96:99], v12 offset:51200
    v_mfma_f32_16x16x32_bf16 v[56:59], v[192:195], v[80:83], v[56:59]
    ds_read_b128 v[108:111], v12 offset:54272
    ds_read_b64_tr_b16 v[222:223], v15 offset:26624
    v_mfma_f32_16x16x32_bf16 v[44:47], v[184:187], v[72:75], v[44:47]
    ds_read_b64 v[122:123], v12 offset:55296
    v_mfma_f32_16x16x32_bf16 v[48:51], v[196:199], v[72:75], v[48:51]
    ds_read_b64 v[126:127], v12 offset:55304
    v_mfma_f32_16x16x32_bf16 v[52:55], v[184:187], v[84:87], v[52:55]
    ds_read_b64_tr_b16 v[226:227], v14 offset:28672
    v_mfma_f32_16x16x32_bf16 v[56:59], v[196:199], v[84:87], v[56:59]
    ds_read_b64_tr_b16 v[230:231], v15 offset:28672
    s_waitcnt lgkmcnt(7)
    v_mfma_f32_16x16x32_bf16 v[44:47], v[200:203], v[88:91], v[44:47]
    v_mfma_f32_16x16x32_bf16 v[48:51], v[212:215], v[88:91], v[48:51]
    v_mfma_f32_16x16x32_bf16 v[52:55], v[200:203], v[100:103], v[52:55]
    v_mfma_f32_16x16x32_bf16 v[56:59], v[212:215], v[100:103], v[56:59]
    v_mfma_f32_16x16x32_bf16 v[44:47], v[204:207], v[92:95], v[44:47]
    v_mfma_f32_16x16x32_bf16 v[48:51], v[216:219], v[92:95], v[48:51]
    v_mfma_f32_16x16x32_bf16 v[52:55], v[204:207], v[104:107], v[52:55]
    v_mfma_f32_16x16x32_bf16 v[56:59], v[216:219], v[104:107], v[56:59]
    s_waitcnt lgkmcnt(0)
    v_mfma_f32_16x16x32_bf16 v[44:47], v[208:211], v[96:99], v[44:47]
    v_mfma_f32_16x16x32_bf16 v[48:51], v[220:223], v[96:99], v[48:51]
    v_mfma_f32_16x16x32_bf16 v[52:55], v[208:211], v[108:111], v[52:55]
    v_mfma_f32_16x16x32_bf16 v[56:59], v[220:223], v[108:111], v[56:59]
    v_mfma_f32_16x16x32_bf16 v[44:47], v[224:227], v[120:123], v[44:47]
    v_mfma_f32_16x16x32_bf16 v[48:51], v[228:231], v[120:123], v[48:51]
    v_mfma_f32_16x16x32_bf16 v[52:55], v[224:227], v[124:127], v[52:55]
    v_mfma_f32_16x16x32_bf16 v[56:59], v[228:231], v[124:127], v[56:59]
    s_waitcnt vmcnt(0)
    s_cmp_eq_u32 s27, 0
    s_cbranch_scc0 f_noa
    s_mov_b32 s47, 0
    s_branch tc_73c
tc_73r:
    s_sleep 1
    buffer_load_dwordx4 v[32:35], v4, s[12:15], s38 offen offset:0 sc0 sc1
    buffer_load_dwordx4 v[36:39], v4, s[12:15], s38 offen offset:1024 sc0 sc1
    buffer_load_dwordx4 v[40:43], v4, s[12:15], s38 offen offset:2048 sc0 sc1
tc_73c:
    s_waitcnt vmcnt(0)
    v_xor_b32 v35, s62, v35
    v_xor_b32 v39, s62, v39
    v_xor_b32 v43, s62, v43
    v_or_b32 v8, v35, v39
    v_or3_b32 v8, v8, v43, v43
    v_cmp_ne_u32 vcc, 0, v8
    s_add_u32 s47, s47, 1
    s_cmp_gt_u32 s47, 0x40000
    s_cbranch_scc1 tc_73x
    s_cbranch_vccnz tc_73r
tc_73x:
    v_lshlrev_b32 v20, 16, v32
    v_and_b32 v21, 0xffff0000, v32
    v_lshlrev_b32 v22, 16, v33
    v_and_b32 v23, 0xffff0000, v33
    v_lshlrev_b32 v24, 16, v34
    v_and_b32 v25, 0xffff0000, v34
    v_lshlrev_b32 v26, 16, v36
    v_and_b32 v27, 0xffff0000, v36
    v_lshlrev_b32 v28, 16, v37
    v_and_b32 v29, 0xffff0000, v37
    v_lshlrev_b32 v30, 16, v38
    v_and_b32 v31, 0xffff0000, v38
    v_lshlrev_b32 v32, 16, v40
    v_and_b32 v33, 0xffff0000, v40
    v_lshlrev_b32 v34, 16, v41
    v_and_b32 v35, 0xffff0000, v41
f_noa:
    s_nop 2
    v_pk_add_f32 v[20:21], v[20:21], v[44:45] neg_lo:[0,1] neg_hi:[0,1]
    v_pk_add_f32 v[22:23], v[22:23], v[46:47] neg_lo:[0,1] neg_hi:[0,1]
    v_pk_add_f32 v[24:25], v[24:25], v[48:49] neg_lo:[0,1] neg_hi:[0,1]
    v_pk_add_f32 v[26:27], v[26:27], v[50:51] neg_lo:[0,1] neg_hi:[0,1]
    v_pk_add_f32 v[28:29], v[28:29], v[52:53] neg_lo:[0,1] neg_hi:[0,1]
    v_pk_add_f32 v[30:31], v[30:31], v[54:55] neg_lo:[0,1] neg_hi:[0,1]
    v_pk_add_f32 v[32:33], v[32:33], v[56:57] neg_lo:[0,1] neg_hi:[0,1]
    v_pk_add_f32 v[34:35], v[34:35], v[58:59] neg_lo:[0,1] neg_hi:[0,1]
    v_pk_fma_f32 v[20:21], v[20:21], v[60:61], v[44:45] op_sel_hi:[1,0,1]
    v_pk_fma_f32 v[22:23], v[22:23], v[60:61], v[46:47] op_sel_hi:[1,0,1]
    v_pk_fma_f32 v[24:25], v[24:25], v[60:61], v[48:49] op_sel_hi:[1,0,1]
    v_pk_fma_f32 v[26:27], v[26:27], v[60:61], v[50:51] op_sel_hi:[1,0,1]
    v_pk_fma_f32 v[28:29], v[28:29], v[62:63], v[52:53] op_sel_hi:[1,0,1]
    v_pk_fma_f32 v[30:31], v[30:31], v[62:63], v[54:55] op_sel_hi:[1,0,1]
    v_pk_fma_f32 v[32:33], v[32:33], v[62:63], v[56:57] op_sel_hi:[1,0,1]
    v_pk_fma_f32 v[34:35], v[34:35], v[62:63], v[58:59] op_sel_hi:[1,0,1]
    v_cvt_pk_bf16_f32 v80, v20, v21
    v_cvt_pk_bf16_f32 v81, v22, v23
    v_cvt_pk_bf16_f32 v82, v24, v25
    v_cvt_pk_bf16_f32 v83, v26, v27
    v_cvt_pk_bf16_f32 v84, v28, v29
    v_cvt_pk_bf16_f32 v85, v30, v31
    v_cvt_pk_bf16_f32 v86, v32, v33
    v_cvt_pk_bf16_f32 v87, v34, v35
    v_permlane16_swap_b32 v80, v82
    v_permlane16_swap_b32 v81, v83
    buffer_store_dwordx4 v[80:83], v7, s[4:7], s40 offen offset:0
    v_permlane16_swap_b32 v84, v86
    v_permlane16_swap_b32 v85, v87
    buffer_store_dwordx4 v[84:87], v7, s[4:7], s40 offen offset:1024
    s_endpgm
f_abl:
    buffer_load_dwordx4 v[32:35], v4, s[12:15], s38 offen offset:0 sc0 sc1
    buffer_load_dwordx4 v[36:39], v4, s[12:15], s38 offen offset:1024 sc0 sc1
    buffer_load_dwordx4 v[40:43], v4, s[12:15], s38 offen offset:2048 sc0 sc1
    s_branch f_ablr
fk_end:
    s_endpgm
.section .rodata,"a"
.p2align 6
.amdhsa_kernel gated_mix__sliding_local_dilated__mixer_gmlp__prompt_kernel
  .amdhsa_next_free_vgpr 256
  .amdhsa_next_free_sgpr 102
  .amdhsa_accum_offset 256
  .amdhsa_group_segment_fixed_size 0
  .amdhsa_kernarg_size 96
  .amdhsa_user_sgpr_count 2
  .amdhsa_user_sgpr_kernarg_segment_ptr 1
  .amdhsa_system_sgpr_workgroup_id_x 1
.end_amdhsa_kernel
```
